```python
import torch

def _softmax(x, axis=-1):
    return torch.softmax(x, dim=axis)
def _gelu(x):
    return torch.nn.functional.gelu(x, approximate="tanh")
def _silu(x):
    return torch.nn.functional.silu(x)
def _sigmoid(x):
    return torch.sigmoid(x)
def _layernorm(x, axis=-1, eps=1e-5):
    m = x.mean(dim=axis, keepdim=True)
    v = x.var(dim=axis, keepdim=True, unbiased=False)
    return (x - m) / torch.sqrt(v + eps)
def _scatter_add(tgt, idx, src, axis=0):
    return tgt.clone().index_add_(axis, idx, src)
def _segment_sum(src, seg, n):
    out = torch.zeros((n,) + src.shape[1:], dtype=src.dtype)
    return out.index_add_(0, seg, src)
def _pad(x, pw):
    flat = tuple(v for pair in reversed(pw) for v in pair)
    return torch.nn.functional.pad(x, flat)

kernel_name = 'gated_mix__mha_block_cached__swiglu_ffn__decode'

def setup_inputs():

    _w = (lambda a: (lambda t: t.to(torch.bfloat16) if t.is_floating_point() else t)(torch.as_tensor(a)))
    def _A_setup():
        B, Sq, D = 8, 1, 576
        H, Sk, Dh = 32, 8192, 128
        return {
            "x": _w((lambda *s: torch.randn(*s, dtype=torch.bfloat16) * 0.05)(B, Sq, D)),
            "k_cache": _w((lambda *s: torch.randn(*s, dtype=torch.bfloat16) * 6.4)(B, H, Sk, Dh)),
            "v_cache": _w((lambda *s: torch.randn(*s, dtype=torch.bfloat16) * 0.4)(B, H, Sk, Dh)),
            "wq": _w((lambda *s: torch.randn(*s, dtype=torch.bfloat16) * 6.4)(D, H * Dh) * (D ** -0.5)),
            "wo": _w((lambda *s: torch.randn(*s, dtype=torch.bfloat16) * 0.4)(H * Dh, D) * ((H * Dh) ** -0.5)),
        }
    _A_in = _A_setup()

    def _B_setup():
        B, S, D, F = 8, 1, 576, 4608
        return {
            "x": _w((lambda *s: torch.randn(*s, dtype=torch.bfloat16) * 0.05)(B, S, D)),
            "w_gate": _w((lambda *s: torch.randn(*s, dtype=torch.bfloat16) * 0.05)(D, F)),
            "w_up": _w((lambda *s: torch.randn(*s, dtype=torch.bfloat16) * 0.05)(D, F)),
            "w_down": _w((lambda *s: torch.randn(*s, dtype=torch.bfloat16) * 0.05)(F, D)),
        }
    _B_in = _B_setup()

    return {
        "A_x": _A_in["x"],
        "A_k_cache": _A_in["k_cache"],
        "A_v_cache": _A_in["v_cache"],
        "A_wq": _A_in["wq"],
        "A_wo": _A_in["wo"],
        "B_x": _B_in["x"],
        "B_w_gate": _B_in["w_gate"],
        "B_w_up": _B_in["w_up"],
        "B_w_down": _B_in["w_down"],
        "gate_w": _w((lambda *s: torch.randn(*s, dtype=torch.bfloat16) * 0.05)(576) * 16.0),
    }

def reference(A_x, A_k_cache, A_v_cache, A_wq, A_wo, B_x, B_w_gate, B_w_up, B_w_down, gate_w):
    def _A_ref(x, k_cache, v_cache, wq, wo):
        B, Sq, D = x.shape
        H, Dh = 32, 128
        q = (lambda x, *d: x.permute(*d))((x @ wq).reshape(B, Sq, H, Dh), 0, 2, 1, 3)
        scores = torch.einsum("bhqd,bhkd->bhqk", q, k_cache) * (Dh ** -0.5)
        p = _softmax(scores, axis=-1)
        o = torch.einsum("bhqk,bhkd->bhqd", p, v_cache)
        return (lambda x, *d: x.permute(*d))(o, 0, 2, 1, 3).reshape(B, Sq, H * Dh) @ wo

    def _B_ref(x, w_gate, w_up, w_down):
        g = _silu(x @ w_gate)
        u = x @ w_up
        return (g * u) @ w_down

    x = A_x
    g = _sigmoid((x * gate_w).sum(-1, keepdims=True))
    a = _A_ref(x, A_k_cache, A_v_cache, A_wq, A_wo)
    b = _B_ref(x, B_w_gate, B_w_up, B_w_down)
    return g * a + (1 - g) * b
```

```asm
; @launch grid=(256,1,1) block=(192,1,1) lds=143680
.amdgcn_target "amdgcn-amd-amdhsa--gfx950"
.text
.globl gated_mix__mha_block_cached__swiglu_ffn__decode_kernel
.p2align 8
.type gated_mix__mha_block_cached__swiglu_ffn__decode_kernel,@function
gated_mix__mha_block_cached__swiglu_ffn__decode_kernel:
    s_cmp_ge_u32 s2, 256
    s_cbranch_scc1 L_end
    s_load_dwordx16 s[4:19], s[0:1], 0
    s_load_dwordx8 s[20:27], s[0:1], 64
    s_load_dwordx2 s[28:29], s[0:1], 96
    v_lshrrev_b32 v1, 6, v0
    v_and_b32 v0, 63, v0
    v_readfirstlane_b32 s3, v1
    v_lshlrev_b32 v1, 4, v0
    s_lshr_b32 s30, s2, 5
    s_and_b32 s31, s2, 31
    s_cmp_eq_u32 s3, 0
    s_cbranch_scc1 L_S
    s_cmp_eq_u32 s3, 2
    s_cbranch_scc1 L_HB
L_HA:
    s_setprio 3
    s_sub_u32 s52, s2, 16
    s_cmp_lt_u32 s52, 128
    s_cbranch_scc0 L_HA_q
    s_branch L_HA_noq
L_HA_q:
    s_waitcnt lgkmcnt(0)
    s_load_dword s88, s[28:29], 0
    s_mov_b32 s48, s28
    s_mov_b32 s49, s29
    s_mov_b32 s50, 2097152
    s_mov_b32 s51, 0x20000
    s_mov_b32 s32, s10
    s_mov_b32 s33, s11
    s_mov_b32 s34, 4718592
    s_mov_b32 s35, 0x20000
    s_mov_b32 s36, s4
    s_mov_b32 s37, s5
    s_mov_b32 s38, 9216
    s_mov_b32 s39, 0x20000
    v_and_b32 v5, 7, v0
    v_mul_u32_u24 v9, 1152, v5
    v_lshrrev_b32 v8, 4, v0
    v_lshl_add_u32 v9, v8, 4, v9
    s_lshr_b32 s52, s2, 3
    s_and_b32 s52, s52, 15
    s_and_b32 s53, s52, 1
    s_bfe_u32 s54, s52, 0x10001
    s_lshr_b32 s52, s52, 2
    s_lshl_b32 s52, s52, 3
    s_and_b32 s55, s2, 7
    s_add_u32 s52, s52, s55
    s_lshl_b32 s52, s52, 1
    s_add_u32 s52, s52, s54
    s_mul_i32 s54, s53, 2359296
    s_lshl_b32 s55, s52, 7
    s_add_u32 s54, s54, s55
    s_mul_i32 s56, s53, 576
    v_lshrrev_b32 v4, 3, v0
    v_lshlrev_b32 v4, 13, v4
    v_lshl_add_u32 v4, v5, 4, v4
    buffer_load_dwordx4 v[72:75], v9, s[36:39], s56 offen offset:0
    buffer_load_dwordx4 v[76:79], v9, s[36:39], s56 offen offset:64
    buffer_load_dwordx4 v[80:83], v9, s[36:39], s56 offen offset:128
    buffer_load_dwordx4 v[84:87], v9, s[36:39], s56 offen offset:192
    buffer_load_dwordx4 v[88:91], v9, s[36:39], s56 offen offset:256
    buffer_load_dwordx4 v[92:95], v9, s[36:39], s56 offen offset:320
    buffer_load_dwordx4 v[96:99], v9, s[36:39], s56 offen offset:384
    buffer_load_dwordx4 v[100:103], v9, s[36:39], s56 offen offset:448
    buffer_load_dwordx4 v[104:107], v9, s[36:39], s56 offen offset:512
    s_mov_b32 m0, 0
    s_nop 0
    buffer_load_dwordx4 v4, s[32:35], s54 offen nt lds
    s_add_u32 s54, s54, 65536
    s_mov_b32 m0, 1024
    s_nop 0
    buffer_load_dwordx4 v4, s[32:35], s54 offen nt lds
    s_add_u32 s54, s54, 65536
    s_mov_b32 m0, 2048
    s_nop 0
    buffer_load_dwordx4 v4, s[32:35], s54 offen nt lds
    s_add_u32 s54, s54, 65536
    s_mov_b32 m0, 3072
    s_nop 0
    buffer_load_dwordx4 v4, s[32:35], s54 offen nt lds
    s_add_u32 s54, s54, 65536
    s_mov_b32 m0, 4096
    s_nop 0
    buffer_load_dwordx4 v4, s[32:35], s54 offen nt lds
    s_add_u32 s54, s54, 65536
    s_mov_b32 m0, 5120
    s_nop 0
    buffer_load_dwordx4 v4, s[32:35], s54 offen nt lds
    s_add_u32 s54, s54, 65536
    s_mov_b32 m0, 6144
    s_nop 0
    buffer_load_dwordx4 v4, s[32:35], s54 offen nt lds
    s_add_u32 s54, s54, 65536
    s_mov_b32 m0, 7168
    s_nop 0
    buffer_load_dwordx4 v4, s[32:35], s54 offen nt lds
    s_add_u32 s54, s54, 65536
    s_mov_b32 m0, 8192
    s_nop 0
    buffer_load_dwordx4 v4, s[32:35], s54 offen nt lds
    s_add_u32 s54, s54, 65536
    s_mov_b32 m0, 9216
    s_nop 0
    buffer_load_dwordx4 v4, s[32:35], s54 offen nt lds
    s_add_u32 s54, s54, 65536
    s_mov_b32 m0, 10240
    s_nop 0
    buffer_load_dwordx4 v4, s[32:35], s54 offen nt lds
    s_add_u32 s54, s54, 65536
    s_mov_b32 m0, 11264
    s_nop 0
    buffer_load_dwordx4 v4, s[32:35], s54 offen nt lds
    s_add_u32 s54, s54, 65536
    s_mov_b32 m0, 12288
    s_nop 0
    buffer_load_dwordx4 v4, s[32:35], s54 offen nt lds
    s_add_u32 s54, s54, 65536
    s_mov_b32 m0, 13312
    s_nop 0
    buffer_load_dwordx4 v4, s[32:35], s54 offen nt lds
    s_add_u32 s54, s54, 65536
    s_mov_b32 m0, 14336
    s_nop 0
    buffer_load_dwordx4 v4, s[32:35], s54 offen nt lds
    s_add_u32 s54, s54, 65536
    s_mov_b32 m0, 15360
    s_nop 0
    buffer_load_dwordx4 v4, s[32:35], s54 offen nt lds
    s_add_u32 s54, s54, 65536
    s_mov_b32 m0, 16384
    s_nop 0
    buffer_load_dwordx4 v4, s[32:35], s54 offen nt lds
    s_add_u32 s54, s54, 65536
    s_mov_b32 m0, 17408
    s_nop 0
    buffer_load_dwordx4 v4, s[32:35], s54 offen nt lds
    s_add_u32 s54, s54, 65536
    s_mov_b32 m0, 18432
    s_nop 0
    buffer_load_dwordx4 v4, s[32:35], s54 offen nt lds
    s_add_u32 s54, s54, 65536
    s_mov_b32 m0, 19456
    s_nop 0
    buffer_load_dwordx4 v4, s[32:35], s54 offen nt lds
    s_add_u32 s54, s54, 65536
    s_mov_b32 m0, 20480
    s_nop 0
    buffer_load_dwordx4 v4, s[32:35], s54 offen nt lds
    s_add_u32 s54, s54, 65536
    s_mov_b32 m0, 21504
    s_nop 0
    buffer_load_dwordx4 v4, s[32:35], s54 offen nt lds
    s_add_u32 s54, s54, 65536
    s_mov_b32 m0, 22528
    s_nop 0
    buffer_load_dwordx4 v4, s[32:35], s54 offen nt lds
    s_add_u32 s54, s54, 65536
    s_mov_b32 m0, 23552
    s_nop 0
    buffer_load_dwordx4 v4, s[32:35], s54 offen nt lds
    s_add_u32 s54, s54, 65536
    s_mov_b32 m0, 24576
    s_nop 0
    buffer_load_dwordx4 v4, s[32:35], s54 offen nt lds
    s_add_u32 s54, s54, 65536
    s_mov_b32 m0, 25600
    s_nop 0
    buffer_load_dwordx4 v4, s[32:35], s54 offen nt lds
    s_add_u32 s54, s54, 65536
    s_mov_b32 m0, 26624
    s_nop 0
    buffer_load_dwordx4 v4, s[32:35], s54 offen nt lds
    s_add_u32 s54, s54, 65536
    s_mov_b32 m0, 27648
    s_nop 0
    buffer_load_dwordx4 v4, s[32:35], s54 offen nt lds
    s_add_u32 s54, s54, 65536
    s_mov_b32 m0, 28672
    s_nop 0
    buffer_load_dwordx4 v4, s[32:35], s54 offen nt lds
    s_add_u32 s54, s54, 65536
    s_mov_b32 m0, 29696
    s_nop 0
    buffer_load_dwordx4 v4, s[32:35], s54 offen nt lds
    s_add_u32 s54, s54, 65536
    s_mov_b32 m0, 30720
    s_nop 0
    buffer_load_dwordx4 v4, s[32:35], s54 offen nt lds
    s_add_u32 s54, s54, 65536
    s_mov_b32 m0, 31744
    s_nop 0
    buffer_load_dwordx4 v4, s[32:35], s54 offen nt lds
    s_add_u32 s54, s54, 65536
    s_mov_b32 m0, 32768
    s_nop 0
    buffer_load_dwordx4 v4, s[32:35], s54 offen nt lds
    s_add_u32 s54, s54, 65536
    s_mov_b32 m0, 33792
    s_nop 0
    buffer_load_dwordx4 v4, s[32:35], s54 offen nt lds
    s_add_u32 s54, s54, 65536
    s_mov_b32 m0, 34816
    s_nop 0
    buffer_load_dwordx4 v4, s[32:35], s54 offen nt lds
    s_add_u32 s54, s54, 65536
    s_mov_b32 m0, 35840
    s_nop 0
    buffer_load_dwordx4 v4, s[32:35], s54 offen nt lds
    s_add_u32 s54, s54, 65536
    v_lshrrev_b32 v6, 4, v0
    v_mul_u32_u24 v6, 8, v6
    v_bfe_u32 v10, v0, 2, 2
    v_add_u32 v6, v6, v10
    v_mul_u32_u24 v6, 128, v6
    v_and_b32 v10, 3, v0
    v_mul_u32_u24 v10, 16, v10
    v_add_u32 v6, v6, v10
    v_and_b32 v10, 8, v0
    v_lshlrev_b32 v12, 1, v10
    v_lshl_add_u32 v12, v8, 5, v12
    v_cmp_ne_u32 s[66:67], 0, v10
    s_waitcnt lgkmcnt(0)
    s_mul_i32 s89, s88, 0x9E3779B1
    s_add_u32 s89, s89, 0x7F4A7C15
    s_add_u32 s88, s88, 1
    s_add_u32 s63, s88, 0
    s_and_b32 s63, s63, 0xff
    v_mov_b32 v60, s63
    s_add_u32 s63, s88, 85
    s_and_b32 s63, s63, 0xff
    v_mov_b32 v61, s63
    s_add_u32 s63, s88, 170
    s_and_b32 s63, s63, 0xff
    v_mov_b32 v62, s63
    s_add_u32 s63, s88, 51
    s_and_b32 s63, s63, 0xff
    v_mov_b32 v63, s63
    s_mov_b32 s59, 0xffffff00
    v_lshlrev_b32 v11, 15, v5
    v_add_u32 v11, v11, v12
    s_lshl_b32 s57, s52, 1
    s_add_u32 s57, s57, s53
    s_lshl_b32 s57, s57, 8
    s_add_u32 s57, s57, 65536
    s_getreg_b32 s65, hwreg(HW_REG_XCC_ID)
    s_and_b32 s65, s65, 15
    s_add_u32 s65, s65, s89
    s_and_b32 s64, s2, 7
    s_mul_i32 s64, s64, 1280
    s_add_u32 s64, s64, 45056
    v_and_b32 v59, 31, v0
    v_lshlrev_b32 v59, 2, v59
    buffer_load_dword v58, v59, s[48:51], s64 offen sc1
    s_waitcnt vmcnt(33)
    ds_read_b64_tr_b16 v[144:145], v6 offset:0
    ds_read_b64_tr_b16 v[146:147], v6 offset:512
    ds_read_b64_tr_b16 v[148:149], v6 offset:8
    ds_read_b64_tr_b16 v[150:151], v6 offset:520
    ds_read_b64_tr_b16 v[152:153], v6 offset:64
    ds_read_b64_tr_b16 v[154:155], v6 offset:576
    ds_read_b64_tr_b16 v[156:157], v6 offset:72
    ds_read_b64_tr_b16 v[158:159], v6 offset:584
    s_waitcnt vmcnt(29)
    ds_read_b64_tr_b16 v[160:161], v6 offset:4096
    ds_read_b64_tr_b16 v[162:163], v6 offset:4608
    ds_read_b64_tr_b16 v[164:165], v6 offset:4104
    ds_read_b64_tr_b16 v[166:167], v6 offset:4616
    ds_read_b64_tr_b16 v[168:169], v6 offset:4160
    ds_read_b64_tr_b16 v[170:171], v6 offset:4672
    ds_read_b64_tr_b16 v[172:173], v6 offset:4168
    ds_read_b64_tr_b16 v[174:175], v6 offset:4680
    s_waitcnt lgkmcnt(8)
    v_mfma_f32_16x16x32_bf16 v[16:19], v[144:147], v[72:75], 0
    v_mfma_f32_16x16x32_bf16 v[20:23], v[148:151], v[72:75], 0
    v_mfma_f32_16x16x32_bf16 v[24:27], v[152:155], v[72:75], 0
    v_mfma_f32_16x16x32_bf16 v[28:31], v[156:159], v[72:75], 0
    s_waitcnt vmcnt(25)
    ds_read_b64_tr_b16 v[144:145], v6 offset:8192
    ds_read_b64_tr_b16 v[146:147], v6 offset:8704
    ds_read_b64_tr_b16 v[148:149], v6 offset:8200
    ds_read_b64_tr_b16 v[150:151], v6 offset:8712
    ds_read_b64_tr_b16 v[152:153], v6 offset:8256
    ds_read_b64_tr_b16 v[154:155], v6 offset:8768
    ds_read_b64_tr_b16 v[156:157], v6 offset:8264
    ds_read_b64_tr_b16 v[158:159], v6 offset:8776
    s_waitcnt lgkmcnt(8)
    v_mfma_f32_16x16x32_bf16 v[16:19], v[160:163], v[76:79], v[16:19]
    v_mfma_f32_16x16x32_bf16 v[20:23], v[164:167], v[76:79], v[20:23]
    v_mfma_f32_16x16x32_bf16 v[24:27], v[168:171], v[76:79], v[24:27]
    v_mfma_f32_16x16x32_bf16 v[28:31], v[172:175], v[76:79], v[28:31]
    s_waitcnt vmcnt(21)
    ds_read_b64_tr_b16 v[160:161], v6 offset:12288
    ds_read_b64_tr_b16 v[162:163], v6 offset:12800
    ds_read_b64_tr_b16 v[164:165], v6 offset:12296
    ds_read_b64_tr_b16 v[166:167], v6 offset:12808
    ds_read_b64_tr_b16 v[168:169], v6 offset:12352
    ds_read_b64_tr_b16 v[170:171], v6 offset:12864
    ds_read_b64_tr_b16 v[172:173], v6 offset:12360
    ds_read_b64_tr_b16 v[174:175], v6 offset:12872
    s_waitcnt lgkmcnt(8)
    v_mfma_f32_16x16x32_bf16 v[16:19], v[144:147], v[80:83], v[16:19]
    v_mfma_f32_16x16x32_bf16 v[20:23], v[148:151], v[80:83], v[20:23]
    v_mfma_f32_16x16x32_bf16 v[24:27], v[152:155], v[80:83], v[24:27]
    v_mfma_f32_16x16x32_bf16 v[28:31], v[156:159], v[80:83], v[28:31]
    s_waitcnt vmcnt(17)
    ds_read_b64_tr_b16 v[144:145], v6 offset:16384
    ds_read_b64_tr_b16 v[146:147], v6 offset:16896
    ds_read_b64_tr_b16 v[148:149], v6 offset:16392
    ds_read_b64_tr_b16 v[150:151], v6 offset:16904
    ds_read_b64_tr_b16 v[152:153], v6 offset:16448
    ds_read_b64_tr_b16 v[154:155], v6 offset:16960
    ds_read_b64_tr_b16 v[156:157], v6 offset:16456
    ds_read_b64_tr_b16 v[158:159], v6 offset:16968
    s_waitcnt lgkmcnt(8)
    v_mfma_f32_16x16x32_bf16 v[16:19], v[160:163], v[84:87], v[16:19]
    v_mfma_f32_16x16x32_bf16 v[20:23], v[164:167], v[84:87], v[20:23]
    v_mfma_f32_16x16x32_bf16 v[24:27], v[168:171], v[84:87], v[24:27]
    v_mfma_f32_16x16x32_bf16 v[28:31], v[172:175], v[84:87], v[28:31]
    s_waitcnt vmcnt(13)
    ds_read_b64_tr_b16 v[160:161], v6 offset:20480
    ds_read_b64_tr_b16 v[162:163], v6 offset:20992
    ds_read_b64_tr_b16 v[164:165], v6 offset:20488
    ds_read_b64_tr_b16 v[166:167], v6 offset:21000
    ds_read_b64_tr_b16 v[168:169], v6 offset:20544
    ds_read_b64_tr_b16 v[170:171], v6 offset:21056
    ds_read_b64_tr_b16 v[172:173], v6 offset:20552
    ds_read_b64_tr_b16 v[174:175], v6 offset:21064
    s_waitcnt lgkmcnt(8)
    v_mfma_f32_16x16x32_bf16 v[16:19], v[144:147], v[88:91], v[16:19]
    v_mfma_f32_16x16x32_bf16 v[20:23], v[148:151], v[88:91], v[20:23]
    v_mfma_f32_16x16x32_bf16 v[24:27], v[152:155], v[88:91], v[24:27]
    v_mfma_f32_16x16x32_bf16 v[28:31], v[156:159], v[88:91], v[28:31]
    s_waitcnt vmcnt(9)
    ds_read_b64_tr_b16 v[144:145], v6 offset:24576
    ds_read_b64_tr_b16 v[146:147], v6 offset:25088
    ds_read_b64_tr_b16 v[148:149], v6 offset:24584
    ds_read_b64_tr_b16 v[150:151], v6 offset:25096
    ds_read_b64_tr_b16 v[152:153], v6 offset:24640
    ds_read_b64_tr_b16 v[154:155], v6 offset:25152
    ds_read_b64_tr_b16 v[156:157], v6 offset:24648
    ds_read_b64_tr_b16 v[158:159], v6 offset:25160
    s_waitcnt lgkmcnt(8)
    v_mfma_f32_16x16x32_bf16 v[16:19], v[160:163], v[92:95], v[16:19]
    v_mfma_f32_16x16x32_bf16 v[20:23], v[164:167], v[92:95], v[20:23]
    v_mfma_f32_16x16x32_bf16 v[24:27], v[168:171], v[92:95], v[24:27]
    v_mfma_f32_16x16x32_bf16 v[28:31], v[172:175], v[92:95], v[28:31]
    s_waitcnt vmcnt(5)
    ds_read_b64_tr_b16 v[160:161], v6 offset:28672
    ds_read_b64_tr_b16 v[162:163], v6 offset:29184
    ds_read_b64_tr_b16 v[164:165], v6 offset:28680
    ds_read_b64_tr_b16 v[166:167], v6 offset:29192
    ds_read_b64_tr_b16 v[168:169], v6 offset:28736
    ds_read_b64_tr_b16 v[170:171], v6 offset:29248
    ds_read_b64_tr_b16 v[172:173], v6 offset:28744
    ds_read_b64_tr_b16 v[174:175], v6 offset:29256
    s_waitcnt lgkmcnt(8)
    v_mfma_f32_16x16x32_bf16 v[16:19], v[144:147], v[96:99], v[16:19]
    v_mfma_f32_16x16x32_bf16 v[20:23], v[148:151], v[96:99], v[20:23]
    v_mfma_f32_16x16x32_bf16 v[24:27], v[152:155], v[96:99], v[24:27]
    v_mfma_f32_16x16x32_bf16 v[28:31], v[156:159], v[96:99], v[28:31]
    s_waitcnt vmcnt(1)
    ds_read_b64_tr_b16 v[144:145], v6 offset:32768
    ds_read_b64_tr_b16 v[146:147], v6 offset:33280
    ds_read_b64_tr_b16 v[148:149], v6 offset:32776
    ds_read_b64_tr_b16 v[150:151], v6 offset:33288
    ds_read_b64_tr_b16 v[152:153], v6 offset:32832
    ds_read_b64_tr_b16 v[154:155], v6 offset:33344
    ds_read_b64_tr_b16 v[156:157], v6 offset:32840
    ds_read_b64_tr_b16 v[158:159], v6 offset:33352
    s_waitcnt lgkmcnt(8)
    v_mfma_f32_16x16x32_bf16 v[16:19], v[160:163], v[100:103], v[16:19]
    v_mfma_f32_16x16x32_bf16 v[20:23], v[164:167], v[100:103], v[20:23]
    v_mfma_f32_16x16x32_bf16 v[24:27], v[168:171], v[100:103], v[24:27]
    v_mfma_f32_16x16x32_bf16 v[28:31], v[172:175], v[100:103], v[28:31]
    s_waitcnt lgkmcnt(0)
    v_mfma_f32_16x16x32_bf16 v[16:19], v[144:147], v[104:107], v[16:19]
    v_mfma_f32_16x16x32_bf16 v[20:23], v[148:151], v[104:107], v[20:23]
    v_mfma_f32_16x16x32_bf16 v[24:27], v[152:155], v[104:107], v[24:27]
    v_mfma_f32_16x16x32_bf16 v[28:31], v[156:159], v[104:107], v[28:31]
    s_waitcnt vmcnt(0)
    v_cmp_ne_u32 vcc, s65, v58
    s_nop 0
    s_cmp_eq_u64 vcc, 0
    s_cselect_b32 s64, 1, 0
    s_nop 6
    v_cndmask_b32 v64, v16, v20, s[66:67]
    v_cndmask_b32 v65, v17, v21, s[66:67]
    v_cndmask_b32 v66, v18, v22, s[66:67]
    v_cndmask_b32 v67, v19, v23, s[66:67]
    v_cndmask_b32 v68, v24, v28, s[66:67]
    v_cndmask_b32 v69, v25, v29, s[66:67]
    v_cndmask_b32 v70, v26, v30, s[66:67]
    v_cndmask_b32 v71, v27, v31, s[66:67]
    v_bfi_b32 v64, s59, v64, v60
    v_bfi_b32 v65, s59, v65, v61
    v_bfi_b32 v66, s59, v66, v62
    v_bfi_b32 v67, s59, v67, v63
    v_bfi_b32 v68, s59, v68, v60
    v_bfi_b32 v69, s59, v69, v61
    v_bfi_b32 v70, s59, v70, v62
    v_bfi_b32 v71, s59, v71, v63
    s_cmp_eq_u32 s64, 1
    s_cbranch_scc1 L_ploc_1
    buffer_store_dwordx4 v[64:67], v11, s[48:51], s57 offen offset:0 sc1
    buffer_store_dwordx4 v[68:71], v11, s[48:51], s57 offen offset:128 sc1
    s_branch L_pdn_2
L_ploc_1:
    buffer_store_dwordx4 v[64:67], v11, s[48:51], s57 offen offset:0
    buffer_store_dwordx4 v[68:71], v11, s[48:51], s57 offen offset:128
L_pdn_2:
    v_mov_b32 v2, 143620
    v_mov_b32 v3, 1
    ds_write_b32 v2, v3
    s_branch L_HA2
L_HB:
    s_setprio 3
    v_mov_b32 v2, 143620
    v_mov_b32 v3, 0
    ds_write_b32 v2, v3
    s_waitcnt lgkmcnt(0)
    s_load_dword s88, s[28:29], 0
    s_mov_b32 s48, s28
    s_mov_b32 s49, s29
    s_mov_b32 s50, 2097152
    s_mov_b32 s51, 0x20000
    v_bfe_u32 v6, v0, 3, 1
    v_lshlrev_b32 v6, 9, v6
    v_bfe_u32 v7, v0, 4, 1
    v_lshl_add_u32 v6, v7, 8, v6
    v_and_b32 v5, 7, v0
    v_lshl_add_u32 v6, v5, 5, v6
    v_lshrrev_b32 v7, 5, v0
    v_lshl_add_u32 v6, v7, 4, v6
    s_lshl_b32 s56, s30, 6
    s_lshl_b32 s57, s31, 1
    s_add_u32 s56, s56, s57
    s_lshl_b32 s56, s56, 9
    s_add_u32 s56, s56, 65536
    v_and_b32 v5, 15, v0
    v_lshlrev_b32 v5, 4, v5
    v_lshl_add_u32 v5, v7, 3, v5
    v_add_u32 v4, 143360, v5
    s_waitcnt lgkmcnt(0)
    s_mul_i32 s89, s88, 0x9E3779B1
    s_add_u32 s89, s89, 0x7F4A7C15
    s_add_u32 s88, s88, 1
    s_add_u32 s63, s88, 0
    s_and_b32 s63, s63, 0xff
    v_mov_b32 v60, s63
    s_add_u32 s63, s88, 85
    s_and_b32 s63, s63, 0xff
    v_mov_b32 v61, s63
    s_add_u32 s63, s88, 170
    s_and_b32 s63, s63, 0xff
    v_mov_b32 v62, s63
    s_add_u32 s63, s88, 51
    s_and_b32 s63, s63, 0xff
    v_mov_b32 v63, s63
    s_mov_b32 s59, 0xffffff00
    s_getreg_b32 s65, hwreg(HW_REG_XCC_ID)
    s_and_b32 s65, s65, 15
    s_add_u32 s65, s65, s89
    s_and_b32 s64, s2, 7
    s_mul_i32 s64, s64, 1280
    s_lshr_b32 s63, s2, 3
    s_lshl_b32 s63, s63, 2
    s_add_u32 s64, s64, s63
    s_add_u32 s64, s64, 45056
    v_mov_b32 v12, 0
    v_mov_b32 v13, s65
    s_mov_b64 exec, 1
    buffer_store_dword v13, v12, s[48:51], s64 offen
    s_mov_b64 exec, -1
    s_sub_u32 s62, s2, 16
    s_cmp_lt_u32 s62, 128
    s_cbranch_scc1 L_qg3
    s_mov_b32 s61, 4096
L_qg:
    s_sub_u32 s61, s61, 1
    s_cbranch_scc1 L_qg3
    s_sleep 1
    ds_read_b32 v3, v2
    s_waitcnt lgkmcnt(0)
    v_readfirstlane_b32 s62, v3
    s_cmp_eq_u32 s62, 0
    s_cbranch_scc1 L_qg
L_qg3:
    s_mov_b32 s62, 2097152
L_poll_11:
    buffer_load_dwordx4 v[16:19], v6, s[48:51], s56 offen sc1 nt
    s_waitcnt vmcnt(0)
    v_xor_b32 v2, v16, v60
    v_xor_b32 v3, v17, v61
    v_bitop3_b32 v2, v2, v18, v62 bitop3:0xf6
    v_bitop3_b32 v3, v3, v19, v63 bitop3:0xf6
    v_or_b32 v2, v2, v3
    v_and_b32 v2, 0xff, v2
    v_cmp_ne_u32 vcc, 0, v2
    s_cbranch_vccz L_pdone_12
    s_sleep 2
    s_sub_u32 s62, s62, 1
    s_cbranch_scc0 L_poll_11
L_pdone_12:
    s_mov_b64 exec, -1
    v_mov_b32 v2, 143624
    v_mov_b32 v3, 0
    ds_write_b32 v2, v3
    v_and_b32 v32, s59, v16
    v_and_b32 v33, s59, v17
    v_and_b32 v34, s59, v18
    v_and_b32 v35, s59, v19
    v_mov_b32 v40, v32
    v_mov_b32 v41, v33
    v_mov_b32 v42, v34
    v_mov_b32 v43, v35
    v_permlane16_swap_b32 v32, v40
    v_permlane16_swap_b32 v33, v41
    v_permlane16_swap_b32 v34, v42
    v_permlane16_swap_b32 v35, v43
    v_add_f32 v32, v32, v40
    v_add_f32 v33, v33, v41
    v_add_f32 v34, v34, v42
    v_add_f32 v35, v35, v43
    v_cvt_pk_bf16_f32 v8, v32, v33
    v_cvt_pk_bf16_f32 v9, v34, v35
    v_mov_b32 v2, 143616
    v_mov_b32 v3, 0
    ds_write_b32 v2, v3
    ds_write_b64 v4, v[8:9]
    s_waitcnt lgkmcnt(0)
    s_barrier
    s_branch L_HB2
L_S:
    s_waitcnt lgkmcnt(0)
    s_load_dword s88, s[28:29], 0
    s_mov_b32 s48, s28
    s_mov_b32 s49, s29
    s_mov_b32 s50, 2097152
    s_mov_b32 s51, 0x20000
    s_lshl_b32 s52, s2, 21
    s_lshr_b32 s53, s2, 11
    s_add_u32 s32, s6, s52
    s_addc_u32 s33, s7, s53
    s_mov_b32 s34, 0x200000
    s_mov_b32 s35, 0x20000
    s_add_u32 s36, s8, s52
    s_addc_u32 s37, s9, s53
    s_mov_b32 s38, 0x200000
    s_mov_b32 s39, 0x20000
    s_mov_b32 s54, 0
    s_mov_b32 s53, 0
    v_lshrrev_b32 v2, 4, v0
    v_and_b32 v3, 3, v0
    v_lshlrev_b32 v3, 4, v3
    v_lshl_add_u32 v28, v2, 6, v3
    v_bfe_u32 v3, v0, 2, 2
    v_lshl_add_u32 v40, v3, 8, v28
    v_add_u32 v41, 65536, v40
    v_and_b32 v3, 15, v0
    v_lshlrev_b32 v3, 4, v3
    v_lshl_add_u32 v42, v2, 10, v3
    v_add_u32 v43, 65536, v42
    v_add_u32 v28, 143360, v28
    v_lshrrev_b32 v4, 3, v0
    v_and_b32 v5, 7, v0
    v_lshlrev_b32 v5, 4, v5
    v_mul_u32_u24 v6, 1152, v4
    v_add_u32 v6, v6, v5
    v_mul_u32_u24 v7, 9216, v4
    v_add_u32 v7, v7, v5
    s_mov_b32 s44, s12
    s_mov_b32 s45, s13
    s_mov_b32 s46, 4718592
    s_mov_b32 s47, 0x20000
    s_and_b32 s68, s2, 7
    s_bfe_u32 s69, s2, 0x10003
    s_lshl_b32 s69, s69, 4
    s_add_u32 s68, s68, s69
    s_mul_i32 s75, s68, 147456
    s_lshr_b32 s69, s2, 4
    s_lshl_b32 s69, s69, 7
    s_add_u32 s75, s75, s69
    s_add_u32 s77, s75, 1179648
    s_mov_b32 s78, 0
    s_cmp_ge_u32 s2, 184
    s_cbranch_scc1 L_S_down
    s_cmp_lt_u32 s2, 40
    s_cbranch_scc1 L_S_light
    s_cmp_lt_u32 s2, 112
    s_cselect_b32 s40, s16, s18
    s_cselect_b32 s41, s17, s19
    s_cselect_b32 s74, 40, 112
    s_mov_b32 s42, 5308416
    s_mov_b32 s43, 0x20000
    s_sub_u32 s74, s2, s74
    s_lshr_b32 s74, s74, 3
    s_and_b32 s76, s2, 7
    s_mul_i32 s76, s76, 9
    s_add_u32 s74, s74, s76
    s_lshl_b32 s74, s74, 7
    s_mov_b32 s76, 73728
    s_branch L_S_big
L_S_down:
    s_sub_u32 s74, s2, 184
    s_and_b32 s68, s74, 7
    s_lshr_b32 s69, s74, 3
    s_mul_i32 s74, s68, 663552
    s_lshl_b32 s69, s69, 7
    s_add_u32 s74, s74, s69
    s_mov_b32 s40, s20
    s_mov_b32 s41, s21
    s_mov_b32 s42, 5308416
    s_mov_b32 s43, 0x20000
    s_mov_b32 s76, 9216
    v_mov_b32 v7, v6
L_S_big:
    s_mov_b32 m0, 36864
    s_waitcnt vmcnt(23)
    buffer_load_dwordx4 v7, s[40:43], s74 offen nt lds
    s_add_u32 s74, s74, s76
    s_mov_b32 m0, 37888
    s_waitcnt vmcnt(23)
    buffer_load_dwordx4 v7, s[40:43], s74 offen nt lds
    s_add_u32 s74, s74, s76
    s_mov_b32 m0, 38912
    s_waitcnt vmcnt(23)
    buffer_load_dwordx4 v7, s[40:43], s74 offen nt lds
    s_add_u32 s74, s74, s76
    s_mov_b32 m0, 39936
    s_waitcnt vmcnt(23)
    buffer_load_dwordx4 v7, s[40:43], s74 offen nt lds
    s_add_u32 s74, s74, s76
    s_mov_b32 m0, 40960
    s_waitcnt vmcnt(23)
    buffer_load_dwordx4 v7, s[40:43], s74 offen nt lds
    s_add_u32 s74, s74, s76
    s_mov_b32 m0, 41984
    s_waitcnt vmcnt(23)
    buffer_load_dwordx4 v7, s[40:43], s74 offen nt lds
    s_add_u32 s74, s74, s76
    s_mov_b32 m0, 43008
    s_waitcnt vmcnt(23)
    buffer_load_dwordx4 v7, s[40:43], s74 offen nt lds
    s_add_u32 s74, s74, s76
    s_mov_b32 m0, 44032
    s_waitcnt vmcnt(23)
    buffer_load_dwordx4 v7, s[40:43], s74 offen nt lds
    s_add_u32 s74, s74, s76
    s_mov_b32 m0, 45056
    s_waitcnt vmcnt(23)
    buffer_load_dwordx4 v7, s[40:43], s74 offen nt lds
    s_add_u32 s74, s74, s76
    s_mov_b32 m0, 46080
    s_waitcnt vmcnt(23)
    buffer_load_dwordx4 v7, s[40:43], s74 offen nt lds
    s_add_u32 s74, s74, s76
    s_mov_b32 m0, 47104
    s_waitcnt vmcnt(23)
    buffer_load_dwordx4 v7, s[40:43], s74 offen nt lds
    s_add_u32 s74, s74, s76
    s_mov_b32 m0, 48128
    s_waitcnt vmcnt(23)
    buffer_load_dwordx4 v7, s[40:43], s74 offen nt lds
    s_add_u32 s74, s74, s76
    s_mov_b32 m0, 49152
    s_waitcnt vmcnt(23)
    buffer_load_dwordx4 v7, s[40:43], s74 offen nt lds
    s_add_u32 s74, s74, s76
    s_mov_b32 m0, 50176
    s_waitcnt vmcnt(23)
    buffer_load_dwordx4 v7, s[40:43], s74 offen nt lds
    s_add_u32 s74, s74, s76
    s_mov_b32 m0, 51200
    s_waitcnt vmcnt(23)
    buffer_load_dwordx4 v7, s[40:43], s74 offen nt lds
    s_add_u32 s74, s74, s76
    s_mov_b32 m0, 52224
    s_waitcnt vmcnt(23)
    buffer_load_dwordx4 v7, s[40:43], s74 offen nt lds
    s_add_u32 s74, s74, s76
    s_mov_b32 m0, 53248
    s_waitcnt vmcnt(23)
    buffer_load_dwordx4 v7, s[40:43], s74 offen nt lds
    s_add_u32 s74, s74, s76
    s_mov_b32 m0, 54272
    s_waitcnt vmcnt(23)
    buffer_load_dwordx4 v7, s[40:43], s74 offen nt lds
    s_add_u32 s74, s74, s76
    s_mov_b32 m0, 55296
    s_waitcnt vmcnt(23)
    buffer_load_dwordx4 v7, s[40:43], s74 offen nt lds
    s_add_u32 s74, s74, s76
    s_mov_b32 m0, 56320
    s_waitcnt vmcnt(23)
    buffer_load_dwordx4 v7, s[40:43], s74 offen nt lds
    s_add_u32 s74, s74, s76
    s_mov_b32 m0, 57344
    s_waitcnt vmcnt(23)
    buffer_load_dwordx4 v7, s[40:43], s74 offen nt lds
    s_add_u32 s74, s74, s76
    s_mov_b32 m0, 58368
    s_waitcnt vmcnt(23)
    buffer_load_dwordx4 v7, s[40:43], s74 offen nt lds
    s_add_u32 s74, s74, s76
    s_mov_b32 m0, 59392
    s_waitcnt vmcnt(23)
    buffer_load_dwordx4 v7, s[40:43], s74 offen nt lds
    s_add_u32 s74, s74, s76
    s_mov_b32 m0, 60416
    s_waitcnt vmcnt(23)
    buffer_load_dwordx4 v7, s[40:43], s74 offen nt lds
    s_add_u32 s74, s74, s76
    s_mov_b32 m0, 61440
    s_waitcnt vmcnt(23)
    buffer_load_dwordx4 v7, s[40:43], s74 offen nt lds
    s_add_u32 s74, s74, s76
    s_mov_b32 m0, 62464
    s_waitcnt vmcnt(23)
    buffer_load_dwordx4 v7, s[40:43], s74 offen nt lds
    s_add_u32 s74, s74, s76
    s_mov_b32 m0, 63488
    s_waitcnt vmcnt(23)
    buffer_load_dwordx4 v7, s[40:43], s74 offen nt lds
    s_add_u32 s74, s74, s76
    s_mov_b32 m0, 64512
    s_waitcnt vmcnt(23)
    buffer_load_dwordx4 v7, s[40:43], s74 offen nt lds
    s_add_u32 s74, s74, s76
    s_mov_b32 m0, 65536
    s_waitcnt vmcnt(23)
    buffer_load_dwordx4 v7, s[40:43], s74 offen nt lds
    s_add_u32 s74, s74, s76
    s_mov_b32 m0, 66560
    s_waitcnt vmcnt(23)
    buffer_load_dwordx4 v7, s[40:43], s74 offen nt lds
    s_add_u32 s74, s74, s76
    s_mov_b32 m0, 67584
    s_waitcnt vmcnt(23)
    buffer_load_dwordx4 v7, s[40:43], s74 offen nt lds
    s_add_u32 s74, s74, s76
    s_mov_b32 m0, 68608
    s_waitcnt vmcnt(23)
    buffer_load_dwordx4 v7, s[40:43], s74 offen nt lds
    s_add_u32 s74, s74, s76
    s_mov_b32 m0, 69632
    s_waitcnt vmcnt(23)
    buffer_load_dwordx4 v7, s[40:43], s74 offen nt lds
    s_add_u32 s74, s74, s76
    s_mov_b32 m0, 70656
    s_waitcnt vmcnt(23)
    buffer_load_dwordx4 v7, s[40:43], s74 offen nt lds
    s_add_u32 s74, s74, s76
    s_mov_b32 m0, 71680
    s_waitcnt vmcnt(23)
    buffer_load_dwordx4 v7, s[40:43], s74 offen nt lds
    s_add_u32 s74, s74, s76
    s_mov_b32 m0, 72704
    s_waitcnt vmcnt(23)
    buffer_load_dwordx4 v7, s[40:43], s74 offen nt lds
    s_add_u32 s74, s74, s76
    s_mov_b32 m0, 73728
    s_waitcnt vmcnt(23)
    buffer_load_dwordx4 v7, s[40:43], s74 offen nt lds
    s_add_u32 s74, s74, s76
    s_mov_b32 m0, 74752
    s_waitcnt vmcnt(23)
    buffer_load_dwordx4 v7, s[40:43], s74 offen nt lds
    s_add_u32 s74, s74, s76
    s_mov_b32 m0, 75776
    s_waitcnt vmcnt(23)
    buffer_load_dwordx4 v7, s[40:43], s74 offen nt lds
    s_add_u32 s74, s74, s76
    s_mov_b32 m0, 76800
    s_waitcnt vmcnt(23)
    buffer_load_dwordx4 v7, s[40:43], s74 offen nt lds
    s_add_u32 s74, s74, s76
    s_mov_b32 m0, 77824
    s_waitcnt vmcnt(23)
    buffer_load_dwordx4 v7, s[40:43], s74 offen nt lds
    s_add_u32 s74, s74, s76
    s_mov_b32 m0, 78848
    s_waitcnt vmcnt(23)
    buffer_load_dwordx4 v7, s[40:43], s74 offen nt lds
    s_add_u32 s74, s74, s76
    s_mov_b32 m0, 79872
    s_waitcnt vmcnt(23)
    buffer_load_dwordx4 v7, s[40:43], s74 offen nt lds
    s_add_u32 s74, s74, s76
    s_mov_b32 m0, 80896
    s_waitcnt vmcnt(23)
    buffer_load_dwordx4 v7, s[40:43], s74 offen nt lds
    s_add_u32 s74, s74, s76
    s_mov_b32 m0, 81920
    s_waitcnt vmcnt(23)
    buffer_load_dwordx4 v7, s[40:43], s74 offen nt lds
    s_add_u32 s74, s74, s76
    s_mov_b32 m0, 82944
    s_waitcnt vmcnt(23)
    buffer_load_dwordx4 v7, s[40:43], s74 offen nt lds
    s_add_u32 s74, s74, s76
    s_mov_b32 m0, 83968
    s_waitcnt vmcnt(23)
    buffer_load_dwordx4 v7, s[40:43], s74 offen nt lds
    s_add_u32 s74, s74, s76
    s_mov_b32 m0, 84992
    s_waitcnt vmcnt(23)
    buffer_load_dwordx4 v7, s[40:43], s74 offen nt lds
    s_add_u32 s74, s74, s76
    s_mov_b32 m0, 86016
    s_waitcnt vmcnt(23)
    buffer_load_dwordx4 v7, s[40:43], s74 offen nt lds
    s_add_u32 s74, s74, s76
    s_mov_b32 m0, 87040
    s_waitcnt vmcnt(23)
    buffer_load_dwordx4 v7, s[40:43], s74 offen nt lds
    s_add_u32 s74, s74, s76
    s_mov_b32 m0, 88064
    s_waitcnt vmcnt(23)
    buffer_load_dwordx4 v7, s[40:43], s74 offen nt lds
    s_add_u32 s74, s74, s76
    s_mov_b32 m0, 89088
    s_waitcnt vmcnt(23)
    buffer_load_dwordx4 v7, s[40:43], s74 offen nt lds
    s_add_u32 s74, s74, s76
    s_mov_b32 m0, 90112
    s_waitcnt vmcnt(23)
    buffer_load_dwordx4 v7, s[40:43], s74 offen nt lds
    s_add_u32 s74, s74, s76
    s_mov_b32 m0, 91136
    s_waitcnt vmcnt(23)
    buffer_load_dwordx4 v7, s[40:43], s74 offen nt lds
    s_add_u32 s74, s74, s76
    s_mov_b32 m0, 92160
    s_waitcnt vmcnt(23)
    buffer_load_dwordx4 v7, s[40:43], s74 offen nt lds
    s_add_u32 s74, s74, s76
    s_mov_b32 m0, 93184
    s_waitcnt vmcnt(23)
    buffer_load_dwordx4 v7, s[40:43], s74 offen nt lds
    s_add_u32 s74, s74, s76
    s_mov_b32 m0, 94208
    s_waitcnt vmcnt(23)
    buffer_load_dwordx4 v7, s[40:43], s74 offen nt lds
    s_add_u32 s74, s74, s76
    s_mov_b32 m0, 95232
    s_waitcnt vmcnt(23)
    buffer_load_dwordx4 v7, s[40:43], s74 offen nt lds
    s_add_u32 s74, s74, s76
    s_mov_b32 m0, 96256
    s_waitcnt vmcnt(23)
    buffer_load_dwordx4 v7, s[40:43], s74 offen nt lds
    s_add_u32 s74, s74, s76
    s_mov_b32 m0, 97280
    s_waitcnt vmcnt(23)
    buffer_load_dwordx4 v7, s[40:43], s74 offen nt lds
    s_add_u32 s74, s74, s76
    s_mov_b32 m0, 98304
    s_waitcnt vmcnt(23)
    buffer_load_dwordx4 v7, s[40:43], s74 offen nt lds
    s_add_u32 s74, s74, s76
    s_mov_b32 m0, 99328
    s_waitcnt vmcnt(23)
    buffer_load_dwordx4 v7, s[40:43], s74 offen nt lds
    s_add_u32 s74, s74, s76
    s_mov_b32 m0, 100352
    s_waitcnt vmcnt(23)
    buffer_load_dwordx4 v7, s[40:43], s74 offen nt lds
    s_add_u32 s74, s74, s76
    s_mov_b32 m0, 101376
    s_waitcnt vmcnt(23)
    buffer_load_dwordx4 v7, s[40:43], s74 offen nt lds
    s_add_u32 s74, s74, s76
    s_mov_b32 m0, 102400
    s_waitcnt vmcnt(23)
    buffer_load_dwordx4 v7, s[40:43], s74 offen nt lds
    s_add_u32 s74, s74, s76
    s_mov_b32 m0, 103424
    s_waitcnt vmcnt(23)
    buffer_load_dwordx4 v7, s[40:43], s74 offen nt lds
    s_add_u32 s74, s74, s76
    s_mov_b32 m0, 104448
    s_waitcnt vmcnt(23)
    buffer_load_dwordx4 v7, s[40:43], s74 offen nt lds
    s_add_u32 s74, s74, s76
    s_mov_b32 m0, 105472
    s_waitcnt vmcnt(23)
    buffer_load_dwordx4 v7, s[40:43], s74 offen nt lds
    s_add_u32 s74, s74, s76
    s_mov_b32 m0, 106496
    s_waitcnt vmcnt(23)
    buffer_load_dwordx4 v7, s[40:43], s74 offen nt lds
    s_add_u32 s74, s74, s76
    s_mov_b32 m0, 107520
    s_waitcnt vmcnt(23)
    buffer_load_dwordx4 v7, s[40:43], s74 offen nt lds
    s_add_u32 s74, s74, s76
    s_mov_b32 m0, 108544
    s_waitcnt vmcnt(23)
    buffer_load_dwordx4 v7, s[40:43], s74 offen nt lds
    s_add_u32 s74, s74, s76
    s_mov_b32 m0, 109568
    s_waitcnt vmcnt(23)
    buffer_load_dwordx4 v7, s[40:43], s74 offen nt lds
    s_add_u32 s74, s74, s76
    s_branch L_S_k
L_S_light:
    s_mov_b32 s78, 36864
    s_cmp_ge_u32 s2, 16
    s_cbranch_scc1 L_S_k
L_S_wo:
    s_add_u32 m0, s78, 0
    s_waitcnt vmcnt(23)
    buffer_load_dwordx4 v6, s[44:47], s75 offen nt lds
    s_add_u32 s75, s75, 9216
    s_add_u32 m0, s78, 1024
    s_waitcnt vmcnt(23)
    buffer_load_dwordx4 v6, s[44:47], s75 offen nt lds
    s_add_u32 s75, s75, 9216
    s_add_u32 m0, s78, 2048
    s_waitcnt vmcnt(23)
    buffer_load_dwordx4 v6, s[44:47], s75 offen nt lds
    s_add_u32 s75, s75, 9216
    s_add_u32 m0, s78, 3072
    s_waitcnt vmcnt(23)
    buffer_load_dwordx4 v6, s[44:47], s75 offen nt lds
    s_add_u32 s75, s75, 9216
    s_add_u32 m0, s78, 4096
    s_waitcnt vmcnt(23)
    buffer_load_dwordx4 v6, s[44:47], s75 offen nt lds
    s_add_u32 s75, s75, 9216
    s_add_u32 m0, s78, 5120
    s_waitcnt vmcnt(23)
    buffer_load_dwordx4 v6, s[44:47], s75 offen nt lds
    s_add_u32 s75, s75, 9216
    s_add_u32 m0, s78, 6144
    s_waitcnt vmcnt(23)
    buffer_load_dwordx4 v6, s[44:47], s75 offen nt lds
    s_add_u32 s75, s75, 9216
    s_add_u32 m0, s78, 7168
    s_waitcnt vmcnt(23)
    buffer_load_dwordx4 v6, s[44:47], s75 offen nt lds
    s_add_u32 s75, s75, 9216
    s_add_u32 m0, s78, 8192
    s_waitcnt vmcnt(23)
    buffer_load_dwordx4 v6, s[44:47], s75 offen nt lds
    s_add_u32 s75, s75, 9216
    s_add_u32 m0, s78, 9216
    s_waitcnt vmcnt(23)
    buffer_load_dwordx4 v6, s[44:47], s75 offen nt lds
    s_add_u32 s75, s75, 9216
    s_add_u32 m0, s78, 10240
    s_waitcnt vmcnt(23)
    buffer_load_dwordx4 v6, s[44:47], s75 offen nt lds
    s_add_u32 s75, s75, 9216
    s_add_u32 m0, s78, 11264
    s_waitcnt vmcnt(23)
    buffer_load_dwordx4 v6, s[44:47], s75 offen nt lds
    s_add_u32 s75, s75, 9216
    s_add_u32 m0, s78, 12288
    s_waitcnt vmcnt(23)
    buffer_load_dwordx4 v6, s[44:47], s75 offen nt lds
    s_add_u32 s75, s75, 9216
    s_add_u32 m0, s78, 13312
    s_waitcnt vmcnt(23)
    buffer_load_dwordx4 v6, s[44:47], s75 offen nt lds
    s_add_u32 s75, s75, 9216
    s_add_u32 m0, s78, 14336
    s_waitcnt vmcnt(23)
    buffer_load_dwordx4 v6, s[44:47], s75 offen nt lds
    s_add_u32 s75, s75, 9216
    s_add_u32 m0, s78, 15360
    s_waitcnt vmcnt(23)
    buffer_load_dwordx4 v6, s[44:47], s75 offen nt lds
    s_add_u32 s75, s75, 9216
    s_add_u32 m0, s78, 16384
    s_waitcnt vmcnt(23)
    buffer_load_dwordx4 v6, s[44:47], s77 offen nt lds
    s_add_u32 s77, s77, 9216
    s_add_u32 m0, s78, 17408
    s_waitcnt vmcnt(23)
    buffer_load_dwordx4 v6, s[44:47], s77 offen nt lds
    s_add_u32 s77, s77, 9216
    s_add_u32 m0, s78, 18432
    s_waitcnt vmcnt(23)
    buffer_load_dwordx4 v6, s[44:47], s77 offen nt lds
    s_add_u32 s77, s77, 9216
    s_add_u32 m0, s78, 19456
    s_waitcnt vmcnt(23)
    buffer_load_dwordx4 v6, s[44:47], s77 offen nt lds
    s_add_u32 s77, s77, 9216
    s_add_u32 m0, s78, 20480
    s_waitcnt vmcnt(23)
    buffer_load_dwordx4 v6, s[44:47], s77 offen nt lds
    s_add_u32 s77, s77, 9216
    s_add_u32 m0, s78, 21504
    s_waitcnt vmcnt(23)
    buffer_load_dwordx4 v6, s[44:47], s77 offen nt lds
    s_add_u32 s77, s77, 9216
    s_add_u32 m0, s78, 22528
    s_waitcnt vmcnt(23)
    buffer_load_dwordx4 v6, s[44:47], s77 offen nt lds
    s_add_u32 s77, s77, 9216
    s_add_u32 m0, s78, 23552
    s_waitcnt vmcnt(23)
    buffer_load_dwordx4 v6, s[44:47], s77 offen nt lds
    s_add_u32 s77, s77, 9216
    s_add_u32 m0, s78, 24576
    s_waitcnt vmcnt(23)
    buffer_load_dwordx4 v6, s[44:47], s77 offen nt lds
    s_add_u32 s77, s77, 9216
    s_add_u32 m0, s78, 25600
    s_waitcnt vmcnt(23)
    buffer_load_dwordx4 v6, s[44:47], s77 offen nt lds
    s_add_u32 s77, s77, 9216
    s_add_u32 m0, s78, 26624
    s_waitcnt vmcnt(23)
    buffer_load_dwordx4 v6, s[44:47], s77 offen nt lds
    s_add_u32 s77, s77, 9216
    s_add_u32 m0, s78, 27648
    s_waitcnt vmcnt(23)
    buffer_load_dwordx4 v6, s[44:47], s77 offen nt lds
    s_add_u32 s77, s77, 9216
    s_add_u32 m0, s78, 28672
    s_waitcnt vmcnt(23)
    buffer_load_dwordx4 v6, s[44:47], s77 offen nt lds
    s_add_u32 s77, s77, 9216
    s_add_u32 m0, s78, 29696
    s_waitcnt vmcnt(23)
    buffer_load_dwordx4 v6, s[44:47], s77 offen nt lds
    s_add_u32 s77, s77, 9216
    s_add_u32 m0, s78, 30720
    s_waitcnt vmcnt(23)
    buffer_load_dwordx4 v6, s[44:47], s77 offen nt lds
    s_add_u32 s77, s77, 9216
    s_add_u32 m0, s78, 31744
    s_waitcnt vmcnt(23)
    buffer_load_dwordx4 v6, s[44:47], s77 offen nt lds
    s_add_u32 s77, s77, 9216
L_S_k:
    s_waitcnt vmcnt(23)
    buffer_load_dwordx4 v[64:67], v40, s[32:35], s54 offen offset:0 nt
    s_waitcnt vmcnt(23)
    buffer_load_dwordx4 v[68:71], v40, s[32:35], s54 offen offset:1024 nt
    s_waitcnt vmcnt(23)
    buffer_load_dwordx4 v[72:75], v40, s[32:35], s54 offen offset:2048 nt
    s_waitcnt vmcnt(23)
    buffer_load_dwordx4 v[76:79], v40, s[32:35], s54 offen offset:3072 nt
    s_waitcnt vmcnt(23)
    buffer_load_dwordx4 v[80:83], v41, s[32:35], s54 offen offset:0 nt
    s_waitcnt vmcnt(23)
    buffer_load_dwordx4 v[84:87], v41, s[32:35], s54 offen offset:1024 nt
    s_waitcnt vmcnt(23)
    buffer_load_dwordx4 v[88:91], v41, s[32:35], s54 offen offset:2048 nt
    s_waitcnt vmcnt(23)
    buffer_load_dwordx4 v[92:95], v41, s[32:35], s54 offen offset:3072 nt
    s_add_u32 s68, s54, 4096
    s_xor_b32 s69, s68, s54
    s_and_b32 s69, s69, 65536
    s_add_u32 s54, s68, s69
    s_waitcnt vmcnt(23)
    buffer_load_dwordx4 v[96:99], v40, s[32:35], s54 offen offset:0 nt
    s_waitcnt vmcnt(23)
    buffer_load_dwordx4 v[100:103], v40, s[32:35], s54 offen offset:1024 nt
    s_waitcnt vmcnt(23)
    buffer_load_dwordx4 v[104:107], v40, s[32:35], s54 offen offset:2048 nt
    s_waitcnt vmcnt(23)
    buffer_load_dwordx4 v[108:111], v40, s[32:35], s54 offen offset:3072 nt
    s_waitcnt vmcnt(23)
    buffer_load_dwordx4 v[112:115], v41, s[32:35], s54 offen offset:0 nt
    s_waitcnt vmcnt(23)
    buffer_load_dwordx4 v[116:119], v41, s[32:35], s54 offen offset:1024 nt
    s_waitcnt vmcnt(23)
    buffer_load_dwordx4 v[120:123], v41, s[32:35], s54 offen offset:2048 nt
    s_waitcnt vmcnt(23)
    buffer_load_dwordx4 v[124:127], v41, s[32:35], s54 offen offset:3072 nt
    s_add_u32 s68, s54, 4096
    s_xor_b32 s69, s68, s54
    s_and_b32 s69, s69, 65536
    s_add_u32 s54, s68, s69
    s_waitcnt vmcnt(23)
    buffer_load_dwordx4 v[128:131], v40, s[32:35], s54 offen offset:0 nt
    s_waitcnt vmcnt(23)
    buffer_load_dwordx4 v[132:135], v40, s[32:35], s54 offen offset:1024 nt
    s_waitcnt vmcnt(23)
    buffer_load_dwordx4 v[136:139], v40, s[32:35], s54 offen offset:2048 nt
    s_waitcnt vmcnt(23)
    buffer_load_dwordx4 v[140:143], v40, s[32:35], s54 offen offset:3072 nt
    v_and_b32 v31, 1, v0
    v_lshlrev_b32 v31, 4, v31
    v_mov_b32 v32, 0xffff
    v_lshlrev_b32 v32, v31, v32
    v_bfe_u32 v31, v0, 1, 3
    v_cmp_eq_u32 vcc, 0, v31
    s_nop 1
    v_cndmask_b32 v8, 0, v32, vcc
    v_cmp_eq_u32 vcc, 1, v31
    s_nop 1
    v_cndmask_b32 v9, 0, v32, vcc
    v_cmp_eq_u32 vcc, 2, v31
    s_nop 1
    v_cndmask_b32 v10, 0, v32, vcc
    v_cmp_eq_u32 vcc, 3, v31
    s_nop 1
    v_cndmask_b32 v11, 0, v32, vcc
    s_waitcnt lgkmcnt(0)
    s_mul_i32 s89, s88, 0x9E3779B1
    s_add_u32 s89, s89, 0x7F4A7C15
    s_add_u32 s88, s88, 1
    s_add_u32 s63, s88, 0
    s_and_b32 s63, s63, 0xff
    v_mov_b32 v60, s63
    s_add_u32 s63, s88, 85
    s_and_b32 s63, s63, 0xff
    v_mov_b32 v61, s63
    s_add_u32 s63, s88, 170
    s_and_b32 s63, s63, 0xff
    v_mov_b32 v62, s63
    s_add_u32 s63, s88, 51
    s_and_b32 s63, s63, 0xff
    v_mov_b32 v63, s63
    s_mov_b32 s59, 0xffffff00
    v_mov_b32 v34, 0xff800000
    v_mov_b32 v36, 0
    v_mov_b32 v24, 0
    v_mov_b32 v25, 0
    v_mov_b32 v26, 0
    v_mov_b32 v27, 0
    s_mov_b32 s55, 0x3fb8aa3b
    s_mov_b32 s56, 0x3db504f3
    s_mov_b32 s70, 0xaaaaaaaa
    s_mov_b32 s71, 0xaaaaaaaa
    s_mov_b32 s72, 0xcccccccc
    s_mov_b32 s73, 0xcccccccc
    v_and_b32 v31, 15, v0
    v_lshlrev_b32 v31, 4, v31
    v_and_b32 v32, 16, v0
    v_lshl_add_u32 v37, v31, 1, v32
    s_lshl_b32 s57, s31, 3
    s_add_u32 s57, s57, s30
    s_lshl_b32 s57, s57, 9
    s_add_u32 s57, s57, 1048576
    s_mov_b32 s63, 0xffff0000
    s_mov_b32 s58, 110592
    v_lshl_add_u32 v38, v0, 2, s58
    s_waitcnt vmcnt(18)
    buffer_load_dwordx4 v[144:147], v41, s[32:35], s54 offen offset:0 nt
    buffer_load_dwordx4 v[148:151], v41, s[32:35], s54 offen offset:1024 nt
    s_waitcnt vmcnt(18)
    buffer_load_dwordx4 v[152:155], v41, s[32:35], s54 offen offset:2048 nt
    buffer_load_dwordx4 v[156:159], v41, s[32:35], s54 offen offset:3072 nt
    s_add_u32 s68, s54, 4096
    s_xor_b32 s69, s68, s54
    s_and_b32 s69, s69, 65536
    s_add_u32 s54, s68, s69
    s_waitcnt vmcnt(18)
    buffer_load_dwordx4 v[160:163], v40, s[32:35], s54 offen offset:0 nt
    buffer_load_dwordx4 v[164:167], v40, s[32:35], s54 offen offset:1024 nt
    s_waitcnt vmcnt(18)
    buffer_load_dwordx4 v[168:171], v40, s[32:35], s54 offen offset:2048 nt
    buffer_load_dwordx4 v[172:175], v40, s[32:35], s54 offen offset:3072 nt
    s_waitcnt vmcnt(18)
    buffer_load_dwordx4 v[176:179], v41, s[32:35], s54 offen offset:0 nt
    buffer_load_dwordx4 v[180:183], v41, s[32:35], s54 offen offset:1024 nt
    s_waitcnt vmcnt(18)
    buffer_load_dwordx4 v[184:187], v41, s[32:35], s54 offen offset:2048 nt
    buffer_load_dwordx4 v[188:191], v41, s[32:35], s54 offen offset:3072 nt
    s_add_u32 s68, s54, 4096
    s_xor_b32 s69, s68, s54
    s_and_b32 s69, s69, 65536
    s_add_u32 s54, s68, s69
    s_barrier
    ds_read_b128 v[4:7], v28
    v_bfe_u32 v31, v0, 2, 2
    v_cmp_eq_u32 s[76:77], 0, v31
    v_cmp_eq_u32 s[78:79], 1, v31
    v_cmp_eq_u32 s[80:81], 2, v31
    v_cmp_eq_u32 s[82:83], 3, v31
    s_waitcnt lgkmcnt(0)
    v_cndmask_b32 v44, 0, v4, s[76:77]
    v_cndmask_b32 v45, 0, v5, s[76:77]
    v_cndmask_b32 v46, 0, v6, s[76:77]
    v_cndmask_b32 v47, 0, v7, s[76:77]
    v_cndmask_b32 v48, 0, v4, s[78:79]
    v_cndmask_b32 v49, 0, v5, s[78:79]
    v_cndmask_b32 v50, 0, v6, s[78:79]
    v_cndmask_b32 v51, 0, v7, s[78:79]
    v_cndmask_b32 v52, 0, v4, s[80:81]
    v_cndmask_b32 v53, 0, v5, s[80:81]
    v_cndmask_b32 v54, 0, v6, s[80:81]
    v_cndmask_b32 v55, 0, v7, s[80:81]
    v_cndmask_b32 v56, 0, v4, s[82:83]
    v_cndmask_b32 v57, 0, v5, s[82:83]
    v_cndmask_b32 v58, 0, v6, s[82:83]
    v_cndmask_b32 v59, 0, v7, s[82:83]
    s_nop 0
    v_mfma_f32_16x16x32_bf16 v[16:19], v[44:47], v[64:67], 0
    v_mfma_f32_16x16x32_bf16 v[16:19], v[48:51], v[68:71], v[16:19]
    s_waitcnt vmcnt(18)
    buffer_load_dwordx4 v[64:67], v40, s[32:35], s54 offen offset:0 nt
    buffer_load_dwordx4 v[68:71], v40, s[32:35], s54 offen offset:1024 nt
    v_mfma_f32_16x16x32_bf16 v[16:19], v[52:55], v[72:75], v[16:19]
    v_mfma_f32_16x16x32_bf16 v[16:19], v[56:59], v[76:79], v[16:19]
    s_waitcnt vmcnt(18)
    buffer_load_dwordx4 v[72:75], v40, s[32:35], s54 offen offset:2048 nt
    buffer_load_dwordx4 v[76:79], v40, s[32:35], s54 offen offset:3072 nt
    v_mfma_f32_16x16x32_bf16 v[20:23], v[44:47], v[80:83], 0
    v_mfma_f32_16x16x32_bf16 v[20:23], v[48:51], v[84:87], v[20:23]
    s_nop 2
    v_cndmask_b32 v12, v16, v17, s[70:71]
    v_cndmask_b32 v13, v18, v19, s[70:71]
    v_cndmask_b32 v14, v12, v13, s[72:73]
    s_waitcnt vmcnt(18)
    buffer_load_dwordx4 v[80:83], v41, s[32:35], s54 offen offset:0 nt
    buffer_load_dwordx4 v[84:87], v41, s[32:35], s54 offen offset:1024 nt
    v_mfma_f32_16x16x32_bf16 v[20:23], v[52:55], v[88:91], v[20:23]
    v_mfma_f32_16x16x32_bf16 v[20:23], v[56:59], v[92:95], v[20:23]
    s_waitcnt vmcnt(18)
    buffer_load_dwordx4 v[88:91], v41, s[32:35], s54 offen offset:2048 nt
    buffer_load_dwordx4 v[92:95], v41, s[32:35], s54 offen offset:3072 nt
    s_add_u32 s68, s54, 4096
    s_xor_b32 s69, s68, s54
    s_and_b32 s69, s69, 65536
    s_add_u32 s54, s68, s69
    v_mfma_f32_16x16x32_bf16 v[16:19], v[44:47], v[96:99], 0
    v_mfma_f32_16x16x32_bf16 v[16:19], v[48:51], v[100:103], v[16:19]
    v_cndmask_b32 v12, v20, v21, s[70:71]
    v_cndmask_b32 v13, v22, v23, s[70:71]
    v_cndmask_b32 v15, v12, v13, s[72:73]
    v_add_f32_dpp v14, v14, v14 quad_perm:[1,0,3,2] row_mask:0xf bank_mask:0xf
    s_nop 0
    v_add_f32_dpp v15, v15, v15 quad_perm:[1,0,3,2] row_mask:0xf bank_mask:0xf
    v_cndmask_b32 v2, v14, v15, s[70:71]
    s_waitcnt vmcnt(18)
    buffer_load_dwordx4 v[96:99], v40, s[32:35], s54 offen offset:0 nt
    buffer_load_dwordx4 v[100:103], v40, s[32:35], s54 offen offset:1024 nt
    v_mfma_f32_16x16x32_bf16 v[16:19], v[52:55], v[104:107], v[16:19]
    v_mfma_f32_16x16x32_bf16 v[16:19], v[56:59], v[108:111], v[16:19]
    s_waitcnt vmcnt(18)
    buffer_load_dwordx4 v[104:107], v40, s[32:35], s54 offen offset:2048 nt
    buffer_load_dwordx4 v[108:111], v40, s[32:35], s54 offen offset:3072 nt
    v_mfma_f32_16x16x32_bf16 v[20:23], v[44:47], v[112:115], 0
    v_mfma_f32_16x16x32_bf16 v[20:23], v[48:51], v[116:119], v[20:23]
    s_nop 2
    v_cndmask_b32 v12, v16, v17, s[70:71]
    v_cndmask_b32 v13, v18, v19, s[70:71]
    v_cndmask_b32 v14, v12, v13, s[72:73]
    s_waitcnt vmcnt(18)
    buffer_load_dwordx4 v[112:115], v41, s[32:35], s54 offen offset:0 nt
    buffer_load_dwordx4 v[116:119], v41, s[32:35], s54 offen offset:1024 nt
    v_mfma_f32_16x16x32_bf16 v[20:23], v[52:55], v[120:123], v[20:23]
    v_mfma_f32_16x16x32_bf16 v[20:23], v[56:59], v[124:127], v[20:23]
    s_waitcnt vmcnt(18)
    buffer_load_dwordx4 v[120:123], v41, s[32:35], s54 offen offset:2048 nt
    buffer_load_dwordx4 v[124:127], v41, s[32:35], s54 offen offset:3072 nt
    s_add_u32 s68, s54, 4096
    s_xor_b32 s69, s68, s54
    s_and_b32 s69, s69, 65536
    s_add_u32 s54, s68, s69
    v_mfma_f32_16x16x32_bf16 v[16:19], v[44:47], v[128:131], 0
    v_mfma_f32_16x16x32_bf16 v[16:19], v[48:51], v[132:135], v[16:19]
    v_cndmask_b32 v12, v20, v21, s[70:71]
    v_cndmask_b32 v13, v22, v23, s[70:71]
    v_cndmask_b32 v15, v12, v13, s[72:73]
    v_add_f32_dpp v14, v14, v14 quad_perm:[1,0,3,2] row_mask:0xf bank_mask:0xf
    s_nop 0
    v_add_f32_dpp v15, v15, v15 quad_perm:[1,0,3,2] row_mask:0xf bank_mask:0xf
    v_cndmask_b32 v3, v14, v15, s[70:71]
    v_add_f32_dpp v2, v2, v2 quad_perm:[2,3,0,1] row_mask:0xf bank_mask:0xf
    s_nop 0
    v_add_f32_dpp v3, v3, v3 quad_perm:[2,3,0,1] row_mask:0xf bank_mask:0xf
    v_cndmask_b32 v30, v2, v3, s[72:73]
    v_cvt_pk_bf16_f32 v30, v30, v30
    v_and_b32 v30, s63, v30
    v_mul_f32 v30, s56, v30
    v_cvt_pk_bf16_f32 v30, v30, v30
    v_and_b32 v30, s63, v30
    v_max_f32 v34, v34, v30
    ds_write_b32 v38, v30 offset:0
    s_waitcnt vmcnt(18)
    buffer_load_dwordx4 v[128:131], v40, s[32:35], s54 offen offset:0 nt
    buffer_load_dwordx4 v[132:135], v40, s[32:35], s54 offen offset:1024 nt
    v_mfma_f32_16x16x32_bf16 v[16:19], v[52:55], v[136:139], v[16:19]
    v_mfma_f32_16x16x32_bf16 v[16:19], v[56:59], v[140:143], v[16:19]
    s_waitcnt vmcnt(18)
    buffer_load_dwordx4 v[136:139], v40, s[32:35], s54 offen offset:2048 nt
    buffer_load_dwordx4 v[140:143], v40, s[32:35], s54 offen offset:3072 nt
    v_mfma_f32_16x16x32_bf16 v[20:23], v[44:47], v[144:147], 0
    v_mfma_f32_16x16x32_bf16 v[20:23], v[48:51], v[148:151], v[20:23]
    s_nop 2
    v_cndmask_b32 v12, v16, v17, s[70:71]
    v_cndmask_b32 v13, v18, v19, s[70:71]
    v_cndmask_b32 v14, v12, v13, s[72:73]
    v_mfma_f32_16x16x32_bf16 v[20:23], v[52:55], v[152:155], v[20:23]
    v_mfma_f32_16x16x32_bf16 v[20:23], v[56:59], v[156:159], v[20:23]
    s_waitcnt vmcnt(18)
    buffer_load_dwordx4 v[144:147], v41, s[32:35], s54 offen offset:0 nt
    buffer_load_dwordx4 v[148:151], v41, s[32:35], s54 offen offset:1024 nt
    v_mfma_f32_16x16x32_bf16 v[16:19], v[44:47], v[160:163], 0
    v_mfma_f32_16x16x32_bf16 v[16:19], v[48:51], v[164:167], v[16:19]
    s_nop 2
    v_cndmask_b32 v12, v20, v21, s[70:71]
    v_cndmask_b32 v13, v22, v23, s[70:71]
    v_cndmask_b32 v15, v12, v13, s[72:73]
    v_add_f32_dpp v14, v14, v14 quad_perm:[1,0,3,2] row_mask:0xf bank_mask:0xf
    s_nop 0
    v_add_f32_dpp v15, v15, v15 quad_perm:[1,0,3,2] row_mask:0xf bank_mask:0xf
    v_cndmask_b32 v2, v14, v15, s[70:71]
    s_waitcnt vmcnt(18)
    buffer_load_dwordx4 v[152:155], v41, s[32:35], s54 offen offset:2048 nt
    buffer_load_dwordx4 v[156:159], v41, s[32:35], s54 offen offset:3072 nt
    s_add_u32 s68, s54, 4096
    s_xor_b32 s69, s68, s54
    s_and_b32 s69, s69, 65536
    s_add_u32 s54, s68, s69
    v_mfma_f32_16x16x32_bf16 v[16:19], v[52:55], v[168:171], v[16:19]
    v_mfma_f32_16x16x32_bf16 v[16:19], v[56:59], v[172:175], v[16:19]
    s_waitcnt vmcnt(18)
    buffer_load_dwordx4 v[160:163], v40, s[32:35], s54 offen offset:0 nt
    buffer_load_dwordx4 v[164:167], v40, s[32:35], s54 offen offset:1024 nt
    v_mfma_f32_16x16x32_bf16 v[20:23], v[44:47], v[176:179], 0
    v_mfma_f32_16x16x32_bf16 v[20:23], v[48:51], v[180:183], v[20:23]
    s_nop 2
    v_cndmask_b32 v12, v16, v17, s[70:71]
    v_cndmask_b32 v13, v18, v19, s[70:71]
    v_cndmask_b32 v14, v12, v13, s[72:73]
    s_waitcnt vmcnt(18)
    buffer_load_dwordx4 v[168:171], v40, s[32:35], s54 offen offset:2048 nt
    buffer_load_dwordx4 v[172:175], v40, s[32:35], s54 offen offset:3072 nt
    v_mfma_f32_16x16x32_bf16 v[20:23], v[52:55], v[184:187], v[20:23]
    v_mfma_f32_16x16x32_bf16 v[20:23], v[56:59], v[188:191], v[20:23]
    s_mov_b32 s58, 62
L_loopK:
    s_waitcnt vmcnt(18)
    buffer_load_dwordx4 v[176:179], v41, s[32:35], s54 offen offset:0 nt
    buffer_load_dwordx4 v[180:183], v41, s[32:35], s54 offen offset:1024 nt
    v_mfma_f32_16x16x32_bf16 v[16:19], v[44:47], v[64:67], 0
    v_mfma_f32_16x16x32_bf16 v[16:19], v[48:51], v[68:71], v[16:19]
    s_nop 1
    v_cndmask_b32 v12, v20, v21, s[70:71]
    v_cndmask_b32 v13, v22, v23, s[70:71]
    v_cndmask_b32 v15, v12, v13, s[72:73]
    v_add_f32_dpp v14, v14, v14 quad_perm:[1,0,3,2] row_mask:0xf bank_mask:0xf
    s_nop 0
    v_add_f32_dpp v15, v15, v15 quad_perm:[1,0,3,2] row_mask:0xf bank_mask:0xf
    v_cndmask_b32 v3, v14, v15, s[70:71]
    v_add_f32_dpp v2, v2, v2 quad_perm:[2,3,0,1] row_mask:0xf bank_mask:0xf
    s_nop 0
    v_add_f32_dpp v3, v3, v3 quad_perm:[2,3,0,1] row_mask:0xf bank_mask:0xf
    v_cndmask_b32 v30, v2, v3, s[72:73]
    v_cvt_pk_bf16_f32 v30, v30, v30
    v_and_b32 v30, s63, v30
    v_mul_f32 v30, s56, v30
    v_cvt_pk_bf16_f32 v30, v30, v30
    v_and_b32 v30, s63, v30
    v_max_f32 v34, v34, v30
    ds_write_b32 v38, v30 offset:256
    v_add_u32 v38, 512, v38
    s_waitcnt vmcnt(18)
    buffer_load_dwordx4 v[184:187], v41, s[32:35], s54 offen offset:2048 nt
    buffer_load_dwordx4 v[188:191], v41, s[32:35], s54 offen offset:3072 nt
    s_add_u32 s68, s54, 4096
    s_xor_b32 s69, s68, s54
    s_and_b32 s69, s69, 65536
    s_add_u32 s54, s68, s69
    v_mfma_f32_16x16x32_bf16 v[16:19], v[52:55], v[72:75], v[16:19]
    v_mfma_f32_16x16x32_bf16 v[16:19], v[56:59], v[76:79], v[16:19]
    s_waitcnt vmcnt(18)
    buffer_load_dwordx4 v[64:67], v40, s[32:35], s54 offen offset:0 nt
    buffer_load_dwordx4 v[68:71], v40, s[32:35], s54 offen offset:1024 nt
    v_mfma_f32_16x16x32_bf16 v[20:23], v[44:47], v[80:83], 0
    v_mfma_f32_16x16x32_bf16 v[20:23], v[48:51], v[84:87], v[20:23]
    s_nop 2
    v_cndmask_b32 v12, v16, v17, s[70:71]
    v_cndmask_b32 v13, v18, v19, s[70:71]
    v_cndmask_b32 v14, v12, v13, s[72:73]
    s_waitcnt vmcnt(18)
    buffer_load_dwordx4 v[72:75], v40, s[32:35], s54 offen offset:2048 nt
    buffer_load_dwordx4 v[76:79], v40, s[32:35], s54 offen offset:3072 nt
    v_mfma_f32_16x16x32_bf16 v[20:23], v[52:55], v[88:91], v[20:23]
    v_mfma_f32_16x16x32_bf16 v[20:23], v[56:59], v[92:95], v[20:23]
    s_waitcnt vmcnt(18)
    buffer_load_dwordx4 v[80:83], v41, s[32:35], s54 offen offset:0 nt
    buffer_load_dwordx4 v[84:87], v41, s[32:35], s54 offen offset:1024 nt
    v_mfma_f32_16x16x32_bf16 v[16:19], v[44:47], v[96:99], 0
    v_mfma_f32_16x16x32_bf16 v[16:19], v[48:51], v[100:103], v[16:19]
    s_nop 2
    v_cndmask_b32 v12, v20, v21, s[70:71]
    v_cndmask_b32 v13, v22, v23, s[70:71]
    v_cndmask_b32 v15, v12, v13, s[72:73]
    v_add_f32_dpp v14, v14, v14 quad_perm:[1,0,3,2] row_mask:0xf bank_mask:0xf
    s_nop 0
    v_add_f32_dpp v15, v15, v15 quad_perm:[1,0,3,2] row_mask:0xf bank_mask:0xf
    v_cndmask_b32 v2, v14, v15, s[70:71]
    s_waitcnt vmcnt(18)
    buffer_load_dwordx4 v[88:91], v41, s[32:35], s54 offen offset:2048 nt
    buffer_load_dwordx4 v[92:95], v41, s[32:35], s54 offen offset:3072 nt
    s_add_u32 s68, s54, 4096
    s_xor_b32 s69, s68, s54
    s_and_b32 s69, s69, 65536
    s_add_u32 s54, s68, s69
    v_mfma_f32_16x16x32_bf16 v[16:19], v[52:55], v[104:107], v[16:19]
    v_mfma_f32_16x16x32_bf16 v[16:19], v[56:59], v[108:111], v[16:19]
    s_waitcnt vmcnt(18)
    buffer_load_dwordx4 v[96:99], v40, s[32:35], s54 offen offset:0 nt
    buffer_load_dwordx4 v[100:103], v40, s[32:35], s54 offen offset:1024 nt
    v_mfma_f32_16x16x32_bf16 v[20:23], v[44:47], v[112:115], 0
    v_mfma_f32_16x16x32_bf16 v[20:23], v[48:51], v[116:119], v[20:23]
    s_nop 2
    v_cndmask_b32 v12, v16, v17, s[70:71]
    v_cndmask_b32 v13, v18, v19, s[70:71]
    v_cndmask_b32 v14, v12, v13, s[72:73]
    s_waitcnt vmcnt(18)
    buffer_load_dwordx4 v[104:107], v40, s[32:35], s54 offen offset:2048 nt
    buffer_load_dwordx4 v[108:111], v40, s[32:35], s54 offen offset:3072 nt
    v_mfma_f32_16x16x32_bf16 v[20:23], v[52:55], v[120:123], v[20:23]
    v_mfma_f32_16x16x32_bf16 v[20:23], v[56:59], v[124:127], v[20:23]
    s_waitcnt vmcnt(18)
    buffer_load_dwordx4 v[112:115], v41, s[32:35], s54 offen offset:0 nt
    buffer_load_dwordx4 v[116:119], v41, s[32:35], s54 offen offset:1024 nt
    v_mfma_f32_16x16x32_bf16 v[16:19], v[44:47], v[128:131], 0
    v_mfma_f32_16x16x32_bf16 v[16:19], v[48:51], v[132:135], v[16:19]
    s_nop 2
    v_cndmask_b32 v12, v20, v21, s[70:71]
    v_cndmask_b32 v13, v22, v23, s[70:71]
    v_cndmask_b32 v15, v12, v13, s[72:73]
    v_add_f32_dpp v14, v14, v14 quad_perm:[1,0,3,2] row_mask:0xf bank_mask:0xf
    s_nop 0
    v_add_f32_dpp v15, v15, v15 quad_perm:[1,0,3,2] row_mask:0xf bank_mask:0xf
    v_cndmask_b32 v3, v14, v15, s[70:71]
    v_add_f32_dpp v2, v2, v2 quad_perm:[2,3,0,1] row_mask:0xf bank_mask:0xf
    s_nop 0
    v_add_f32_dpp v3, v3, v3 quad_perm:[2,3,0,1] row_mask:0xf bank_mask:0xf
    v_cndmask_b32 v30, v2, v3, s[72:73]
    v_cvt_pk_bf16_f32 v30, v30, v30
    v_and_b32 v30, s63, v30
    v_mul_f32 v30, s56, v30
    v_cvt_pk_bf16_f32 v30, v30, v30
    v_and_b32 v30, s63, v30
    v_max_f32 v34, v34, v30
    ds_write_b32 v38, v30 offset:0
    s_waitcnt vmcnt(18)
    buffer_load_dwordx4 v[120:123], v41, s[32:35], s54 offen offset:2048 nt
    buffer_load_dwordx4 v[124:127], v41, s[32:35], s54 offen offset:3072 nt
    s_add_u32 s68, s54, 4096
    s_xor_b32 s69, s68, s54
    s_and_b32 s69, s69, 65536
    s_add_u32 s54, s68, s69
    v_mfma_f32_16x16x32_bf16 v[16:19], v[52:55], v[136:139], v[16:19]
    v_mfma_f32_16x16x32_bf16 v[16:19], v[56:59], v[140:143], v[16:19]
    s_waitcnt vmcnt(18)
    buffer_load_dwordx4 v[128:131], v40, s[32:35], s54 offen offset:0 nt
    buffer_load_dwordx4 v[132:135], v40, s[32:35], s54 offen offset:1024 nt
    v_mfma_f32_16x16x32_bf16 v[20:23], v[44:47], v[144:147], 0
    v_mfma_f32_16x16x32_bf16 v[20:23], v[48:51], v[148:151], v[20:23]
    s_nop 2
    v_cndmask_b32 v12, v16, v17, s[70:71]
    v_cndmask_b32 v13, v18, v19, s[70:71]
    v_cndmask_b32 v14, v12, v13, s[72:73]
    s_waitcnt vmcnt(18)
    buffer_load_dwordx4 v[136:139], v40, s[32:35], s54 offen offset:2048 nt
    buffer_load_dwordx4 v[140:143], v40, s[32:35], s54 offen offset:3072 nt
    v_mfma_f32_16x16x32_bf16 v[20:23], v[52:55], v[152:155], v[20:23]
    v_mfma_f32_16x16x32_bf16 v[20:23], v[56:59], v[156:159], v[20:23]
    s_waitcnt vmcnt(18)
    buffer_load_dwordx4 v[144:147], v41, s[32:35], s54 offen offset:0 nt
    buffer_load_dwordx4 v[148:151], v41, s[32:35], s54 offen offset:1024 nt
    v_mfma_f32_16x16x32_bf16 v[16:19], v[44:47], v[160:163], 0
    v_mfma_f32_16x16x32_bf16 v[16:19], v[48:51], v[164:167], v[16:19]
    s_nop 2
    v_cndmask_b32 v12, v20, v21, s[70:71]
    v_cndmask_b32 v13, v22, v23, s[70:71]
    v_cndmask_b32 v15, v12, v13, s[72:73]
    v_add_f32_dpp v14, v14, v14 quad_perm:[1,0,3,2] row_mask:0xf bank_mask:0xf
    s_nop 0
    v_add_f32_dpp v15, v15, v15 quad_perm:[1,0,3,2] row_mask:0xf bank_mask:0xf
    v_cndmask_b32 v2, v14, v15, s[70:71]
    s_waitcnt vmcnt(18)
    buffer_load_dwordx4 v[152:155], v41, s[32:35], s54 offen offset:2048 nt
    buffer_load_dwordx4 v[156:159], v41, s[32:35], s54 offen offset:3072 nt
    s_add_u32 s68, s54, 4096
    s_xor_b32 s69, s68, s54
    s_and_b32 s69, s69, 65536
    s_add_u32 s54, s68, s69
    v_mfma_f32_16x16x32_bf16 v[16:19], v[52:55], v[168:171], v[16:19]
    v_mfma_f32_16x16x32_bf16 v[16:19], v[56:59], v[172:175], v[16:19]
    s_waitcnt vmcnt(18)
    buffer_load_dwordx4 v[160:163], v40, s[32:35], s54 offen offset:0 nt
    buffer_load_dwordx4 v[164:167], v40, s[32:35], s54 offen offset:1024 nt
    v_mfma_f32_16x16x32_bf16 v[20:23], v[44:47], v[176:179], 0
    v_mfma_f32_16x16x32_bf16 v[20:23], v[48:51], v[180:183], v[20:23]
    s_nop 2
    v_cndmask_b32 v12, v16, v17, s[70:71]
    v_cndmask_b32 v13, v18, v19, s[70:71]
    v_cndmask_b32 v14, v12, v13, s[72:73]
    s_waitcnt vmcnt(18)
    buffer_load_dwordx4 v[168:171], v40, s[32:35], s54 offen offset:2048 nt
    buffer_load_dwordx4 v[172:175], v40, s[32:35], s54 offen offset:3072 nt
    v_mfma_f32_16x16x32_bf16 v[20:23], v[52:55], v[184:187], v[20:23]
    v_mfma_f32_16x16x32_bf16 v[20:23], v[56:59], v[188:191], v[20:23]
L_Kdisp:
    s_sub_u32 s58, s58, 1
    s_cmp_eq_u32 s58, 47
    s_cbranch_scc1 L_midC
L_midCback:
    s_cmp_lg_u32 s58, 0
    s_cbranch_scc1 L_loopK
    s_waitcnt vmcnt(18)
    buffer_load_dwordx4 v[176:179], v41, s[32:35], s54 offen offset:0 nt
    buffer_load_dwordx4 v[180:183], v41, s[32:35], s54 offen offset:1024 nt
    v_mfma_f32_16x16x32_bf16 v[16:19], v[44:47], v[64:67], 0
    v_mfma_f32_16x16x32_bf16 v[16:19], v[48:51], v[68:71], v[16:19]
    v_cndmask_b32 v12, v20, v21, s[70:71]
    v_cndmask_b32 v13, v22, v23, s[70:71]
    v_cndmask_b32 v15, v12, v13, s[72:73]
    v_add_f32_dpp v14, v14, v14 quad_perm:[1,0,3,2] row_mask:0xf bank_mask:0xf
    s_nop 0
    v_add_f32_dpp v15, v15, v15 quad_perm:[1,0,3,2] row_mask:0xf bank_mask:0xf
    v_cndmask_b32 v3, v14, v15, s[70:71]
    v_add_f32_dpp v2, v2, v2 quad_perm:[2,3,0,1] row_mask:0xf bank_mask:0xf
    s_nop 0
    v_add_f32_dpp v3, v3, v3 quad_perm:[2,3,0,1] row_mask:0xf bank_mask:0xf
    v_cndmask_b32 v30, v2, v3, s[72:73]
    v_cvt_pk_bf16_f32 v30, v30, v30
    v_and_b32 v30, s63, v30
    v_mul_f32 v30, s56, v30
    v_cvt_pk_bf16_f32 v30, v30, v30
    v_and_b32 v30, s63, v30
    v_max_f32 v34, v34, v30
    ds_write_b32 v38, v30 offset:256
    v_add_u32 v38, 512, v38
    s_waitcnt vmcnt(18)
    buffer_load_dwordx4 v[184:187], v41, s[32:35], s54 offen offset:2048 nt
    buffer_load_dwordx4 v[188:191], v41, s[32:35], s54 offen offset:3072 nt
    s_add_u32 s68, s54, 4096
    s_xor_b32 s69, s68, s54
    s_and_b32 s69, s69, 65536
    s_add_u32 s54, s68, s69
    v_mfma_f32_16x16x32_bf16 v[16:19], v[52:55], v[72:75], v[16:19]
    v_mfma_f32_16x16x32_bf16 v[16:19], v[56:59], v[76:79], v[16:19]
    s_waitcnt vmcnt(18)
    buffer_load_dwordx4 v[64:67], v42, s[36:39], s53 offen offset:0 nt
    buffer_load_dwordx4 v[68:71], v42, s[36:39], s53 offen offset:256 nt
    v_mfma_f32_16x16x32_bf16 v[20:23], v[44:47], v[80:83], 0
    v_mfma_f32_16x16x32_bf16 v[20:23], v[48:51], v[84:87], v[20:23]
    s_nop 2
    v_cndmask_b32 v12, v16, v17, s[70:71]
    v_cndmask_b32 v13, v18, v19, s[70:71]
    v_cndmask_b32 v14, v12, v13, s[72:73]
    s_waitcnt vmcnt(18)
    buffer_load_dwordx4 v[72:75], v42, s[36:39], s53 offen offset:512 nt
    buffer_load_dwordx4 v[76:79], v42, s[36:39], s53 offen offset:768 nt
    v_mfma_f32_16x16x32_bf16 v[20:23], v[52:55], v[88:91], v[20:23]
    v_mfma_f32_16x16x32_bf16 v[20:23], v[56:59], v[92:95], v[20:23]
    s_waitcnt vmcnt(18)
    buffer_load_dwordx4 v[80:83], v43, s[36:39], s53 offen offset:0 nt
    buffer_load_dwordx4 v[84:87], v43, s[36:39], s53 offen offset:256 nt
    v_mfma_f32_16x16x32_bf16 v[16:19], v[44:47], v[96:99], 0
    v_mfma_f32_16x16x32_bf16 v[16:19], v[48:51], v[100:103], v[16:19]
    s_nop 2
    v_cndmask_b32 v12, v20, v21, s[70:71]
    v_cndmask_b32 v13, v22, v23, s[70:71]
    v_cndmask_b32 v15, v12, v13, s[72:73]
    v_add_f32_dpp v14, v14, v14 quad_perm:[1,0,3,2] row_mask:0xf bank_mask:0xf
    s_nop 0
    v_add_f32_dpp v15, v15, v15 quad_perm:[1,0,3,2] row_mask:0xf bank_mask:0xf
    v_cndmask_b32 v2, v14, v15, s[70:71]
    s_waitcnt vmcnt(18)
    buffer_load_dwordx4 v[88:91], v43, s[36:39], s53 offen offset:512 nt
    buffer_load_dwordx4 v[92:95], v43, s[36:39], s53 offen offset:768 nt
    s_add_u32 s68, s53, 4096
    s_xor_b32 s69, s68, s53
    s_and_b32 s69, s69, 65536
    s_add_u32 s53, s68, s69
    v_mfma_f32_16x16x32_bf16 v[16:19], v[52:55], v[104:107], v[16:19]
    v_mfma_f32_16x16x32_bf16 v[16:19], v[56:59], v[108:111], v[16:19]
    s_waitcnt vmcnt(18)
    buffer_load_dwordx4 v[96:99], v42, s[36:39], s53 offen offset:0 nt
    buffer_load_dwordx4 v[100:103], v42, s[36:39], s53 offen offset:256 nt
    v_mfma_f32_16x16x32_bf16 v[20:23], v[44:47], v[112:115], 0
    v_mfma_f32_16x16x32_bf16 v[20:23], v[48:51], v[116:119], v[20:23]
    s_nop 2
    v_cndmask_b32 v12, v16, v17, s[70:71]
    v_cndmask_b32 v13, v18, v19, s[70:71]
    v_cndmask_b32 v14, v12, v13, s[72:73]
    s_waitcnt vmcnt(18)
    buffer_load_dwordx4 v[104:107], v42, s[36:39], s53 offen offset:512 nt
    buffer_load_dwordx4 v[108:111], v42, s[36:39], s53 offen offset:768 nt
    v_mfma_f32_16x16x32_bf16 v[20:23], v[52:55], v[120:123], v[20:23]
    v_mfma_f32_16x16x32_bf16 v[20:23], v[56:59], v[124:127], v[20:23]
    s_waitcnt vmcnt(18)
    buffer_load_dwordx4 v[112:115], v43, s[36:39], s53 offen offset:0 nt
    buffer_load_dwordx4 v[116:119], v43, s[36:39], s53 offen offset:256 nt
    v_mfma_f32_16x16x32_bf16 v[16:19], v[44:47], v[128:131], 0
    v_mfma_f32_16x16x32_bf16 v[16:19], v[48:51], v[132:135], v[16:19]
    s_nop 2
    v_cndmask_b32 v12, v20, v21, s[70:71]
    v_cndmask_b32 v13, v22, v23, s[70:71]
    v_cndmask_b32 v15, v12, v13, s[72:73]
    v_add_f32_dpp v14, v14, v14 quad_perm:[1,0,3,2] row_mask:0xf bank_mask:0xf
    s_nop 0
    v_add_f32_dpp v15, v15, v15 quad_perm:[1,0,3,2] row_mask:0xf bank_mask:0xf
    v_cndmask_b32 v3, v14, v15, s[70:71]
    v_add_f32_dpp v2, v2, v2 quad_perm:[2,3,0,1] row_mask:0xf bank_mask:0xf
    s_nop 0
    v_add_f32_dpp v3, v3, v3 quad_perm:[2,3,0,1] row_mask:0xf bank_mask:0xf
    v_cndmask_b32 v30, v2, v3, s[72:73]
    v_cvt_pk_bf16_f32 v30, v30, v30
    v_and_b32 v30, s63, v30
    v_mul_f32 v30, s56, v30
    v_cvt_pk_bf16_f32 v30, v30, v30
    v_and_b32 v30, s63, v30
    v_max_f32 v34, v34, v30
    ds_write_b32 v38, v30 offset:0
    s_waitcnt vmcnt(18)
    buffer_load_dwordx4 v[120:123], v43, s[36:39], s53 offen offset:512 nt
    buffer_load_dwordx4 v[124:127], v43, s[36:39], s53 offen offset:768 nt
    s_add_u32 s68, s53, 4096
    s_xor_b32 s69, s68, s53
    s_and_b32 s69, s69, 65536
    s_add_u32 s53, s68, s69
    v_mfma_f32_16x16x32_bf16 v[16:19], v[52:55], v[136:139], v[16:19]
    v_mfma_f32_16x16x32_bf16 v[16:19], v[56:59], v[140:143], v[16:19]
    s_waitcnt vmcnt(18)
    buffer_load_dwordx4 v[128:131], v42, s[36:39], s53 offen offset:0 nt
    buffer_load_dwordx4 v[132:135], v42, s[36:39], s53 offen offset:256 nt
    v_mfma_f32_16x16x32_bf16 v[20:23], v[44:47], v[144:147], 0
    v_mfma_f32_16x16x32_bf16 v[20:23], v[48:51], v[148:151], v[20:23]
    s_nop 2
    v_cndmask_b32 v12, v16, v17, s[70:71]
    v_cndmask_b32 v13, v18, v19, s[70:71]
    v_cndmask_b32 v14, v12, v13, s[72:73]
    s_waitcnt vmcnt(18)
    buffer_load_dwordx4 v[136:139], v42, s[36:39], s53 offen offset:512 nt
    buffer_load_dwordx4 v[140:143], v42, s[36:39], s53 offen offset:768 nt
    v_mfma_f32_16x16x32_bf16 v[20:23], v[52:55], v[152:155], v[20:23]
    v_mfma_f32_16x16x32_bf16 v[20:23], v[56:59], v[156:159], v[20:23]
    s_waitcnt vmcnt(18)
    buffer_load_dwordx4 v[144:147], v43, s[36:39], s53 offen offset:0 nt
    buffer_load_dwordx4 v[148:151], v43, s[36:39], s53 offen offset:256 nt
    v_mfma_f32_16x16x32_bf16 v[16:19], v[44:47], v[160:163], 0
    v_mfma_f32_16x16x32_bf16 v[16:19], v[48:51], v[164:167], v[16:19]
    s_nop 2
    v_cndmask_b32 v12, v20, v21, s[70:71]
    v_cndmask_b32 v13, v22, v23, s[70:71]
    v_cndmask_b32 v15, v12, v13, s[72:73]
    v_add_f32_dpp v14, v14, v14 quad_perm:[1,0,3,2] row_mask:0xf bank_mask:0xf
    s_nop 0
    v_add_f32_dpp v15, v15, v15 quad_perm:[1,0,3,2] row_mask:0xf bank_mask:0xf
    v_cndmask_b32 v2, v14, v15, s[70:71]
    s_waitcnt vmcnt(18)
    buffer_load_dwordx4 v[152:155], v43, s[36:39], s53 offen offset:512 nt
    buffer_load_dwordx4 v[156:159], v43, s[36:39], s53 offen offset:768 nt
    s_add_u32 s68, s53, 4096
    s_xor_b32 s69, s68, s53
    s_and_b32 s69, s69, 65536
    s_add_u32 s53, s68, s69
    v_mfma_f32_16x16x32_bf16 v[16:19], v[52:55], v[168:171], v[16:19]
    v_mfma_f32_16x16x32_bf16 v[16:19], v[56:59], v[172:175], v[16:19]
    s_waitcnt vmcnt(18)
    buffer_load_dwordx4 v[160:163], v42, s[36:39], s53 offen offset:0 nt
    buffer_load_dwordx4 v[164:167], v42, s[36:39], s53 offen offset:256 nt
    v_mfma_f32_16x16x32_bf16 v[20:23], v[44:47], v[176:179], 0
    v_mfma_f32_16x16x32_bf16 v[20:23], v[48:51], v[180:183], v[20:23]
    s_nop 2
    v_cndmask_b32 v12, v16, v17, s[70:71]
    v_cndmask_b32 v13, v18, v19, s[70:71]
    v_cndmask_b32 v14, v12, v13, s[72:73]
    s_waitcnt vmcnt(18)
    buffer_load_dwordx4 v[168:171], v42, s[36:39], s53 offen offset:512 nt
    buffer_load_dwordx4 v[172:175], v42, s[36:39], s53 offen offset:768 nt
    v_mfma_f32_16x16x32_bf16 v[20:23], v[52:55], v[184:187], v[20:23]
    v_mfma_f32_16x16x32_bf16 v[20:23], v[56:59], v[188:191], v[20:23]
    s_nop 7
    v_cndmask_b32 v12, v20, v21, s[70:71]
    v_cndmask_b32 v13, v22, v23, s[70:71]
    v_cndmask_b32 v15, v12, v13, s[72:73]
    v_add_f32_dpp v14, v14, v14 quad_perm:[1,0,3,2] row_mask:0xf bank_mask:0xf
    s_nop 0
    v_add_f32_dpp v15, v15, v15 quad_perm:[1,0,3,2] row_mask:0xf bank_mask:0xf
    v_cndmask_b32 v3, v14, v15, s[70:71]
    v_add_f32_dpp v2, v2, v2 quad_perm:[2,3,0,1] row_mask:0xf bank_mask:0xf
    s_nop 0
    v_add_f32_dpp v3, v3, v3 quad_perm:[2,3,0,1] row_mask:0xf bank_mask:0xf
    v_cndmask_b32 v30, v2, v3, s[72:73]
    v_cvt_pk_bf16_f32 v30, v30, v30
    v_and_b32 v30, s63, v30
    v_mul_f32 v30, s56, v30
    v_cvt_pk_bf16_f32 v30, v30, v30
    v_and_b32 v30, s63, v30
    v_max_f32 v34, v34, v30
    ds_write_b32 v38, v30 offset:256
    v_subrev_u32 v38, 32256, v38
    ds_read_b32 v30, v38
    v_mov_b32 v13, 143616
    v_max_f32_dpp v34, v34, v34 row_ror:8 row_mask:0xf bank_mask:0xf
    s_nop 1
    v_max_f32_dpp v34, v34, v34 row_ror:4 row_mask:0xf bank_mask:0xf
    s_nop 1
    v_max_f32_dpp v34, v34, v34 row_ror:2 row_mask:0xf bank_mask:0xf
    s_nop 1
    v_max_f32_dpp v34, v34, v34 row_ror:1 row_mask:0xf bank_mask:0xf
    s_nop 1
    v_mov_b32 v31, v34
    s_nop 1
    v_permlane16_swap_b32 v34, v31
    v_max_f32 v34, v34, v31
    v_mov_b32 v31, v34
    s_nop 1
    v_permlane32_swap_b32 v34, v31
    v_max_f32 v34, v34, v31
    v_mul_f32 v35, s55, v34
    s_barrier
    s_waitcnt lgkmcnt(0)
    v_fma_f32 v31, v30, s55, -v35
    v_exp_f32 v31, v31
    ds_read_b32 v30, v38 offset:256
    v_cvt_pk_bf16_f32 v33, v31, v31
    v_add_f32 v36, v36, v31
    s_nop 0
    v_and_b32_dpp v16, v33, v8 row_newbcast:0 row_mask:0xf bank_mask:0xf
    v_and_b32_dpp v17, v33, v9 row_newbcast:0 row_mask:0xf bank_mask:0xf
    v_and_b32_dpp v18, v33, v10 row_newbcast:0 row_mask:0xf bank_mask:0xf
    v_and_b32_dpp v19, v33, v11 row_newbcast:0 row_mask:0xf bank_mask:0xf
    v_and_b32_dpp v20, v33, v8 row_newbcast:4 row_mask:0xf bank_mask:0xf
    v_and_b32_dpp v21, v33, v9 row_newbcast:4 row_mask:0xf bank_mask:0xf
    v_and_b32_dpp v22, v33, v10 row_newbcast:4 row_mask:0xf bank_mask:0xf
    v_and_b32_dpp v23, v33, v11 row_newbcast:4 row_mask:0xf bank_mask:0xf
    s_mov_b32 s58, 62
    s_mov_b32 s75, 4278653475
    s_and_b32 s74, s75, 0xff
L_loopV:
    ds_read_b32 v32, v13
    s_waitcnt vmcnt(18)
    buffer_load_dwordx4 v[176:179], v43, s[36:39], s53 offen offset:0 nt
    buffer_load_dwordx4 v[180:183], v43, s[36:39], s53 offen offset:256 nt
    v_mfma_f32_16x16x32_bf16 v[24:27], v[16:19], v[64:67], v[24:27]
    v_mfma_f32_16x16x32_bf16 v[24:27], v[20:23], v[68:71], v[24:27]
    v_and_b32_dpp v16, v33, v8 row_newbcast:8 row_mask:0xf bank_mask:0xf
    v_and_b32_dpp v17, v33, v9 row_newbcast:8 row_mask:0xf bank_mask:0xf
    v_and_b32_dpp v18, v33, v10 row_newbcast:8 row_mask:0xf bank_mask:0xf
    v_and_b32_dpp v19, v33, v11 row_newbcast:8 row_mask:0xf bank_mask:0xf
    v_and_b32_dpp v20, v33, v8 row_newbcast:12 row_mask:0xf bank_mask:0xf
    v_and_b32_dpp v21, v33, v9 row_newbcast:12 row_mask:0xf bank_mask:0xf
    v_and_b32_dpp v22, v33, v10 row_newbcast:12 row_mask:0xf bank_mask:0xf
    v_and_b32_dpp v23, v33, v11 row_newbcast:12 row_mask:0xf bank_mask:0xf
    s_waitcnt vmcnt(18)
    buffer_load_dwordx4 v[184:187], v43, s[36:39], s53 offen offset:512 nt
    buffer_load_dwordx4 v[188:191], v43, s[36:39], s53 offen offset:768 nt
    s_add_u32 s68, s53, 4096
    s_xor_b32 s69, s68, s53
    s_and_b32 s69, s69, 65536
    s_add_u32 s53, s68, s69
    v_mfma_f32_16x16x32_bf16 v[24:27], v[16:19], v[72:75], v[24:27]
    v_mfma_f32_16x16x32_bf16 v[24:27], v[20:23], v[76:79], v[24:27]
    v_and_b32_dpp v16, v33, v8 row_newbcast:1 row_mask:0xf bank_mask:0xf
    v_and_b32_dpp v17, v33, v9 row_newbcast:1 row_mask:0xf bank_mask:0xf
    v_and_b32_dpp v18, v33, v10 row_newbcast:1 row_mask:0xf bank_mask:0xf
    v_and_b32_dpp v19, v33, v11 row_newbcast:1 row_mask:0xf bank_mask:0xf
    v_and_b32_dpp v20, v33, v8 row_newbcast:5 row_mask:0xf bank_mask:0xf
    v_and_b32_dpp v21, v33, v9 row_newbcast:5 row_mask:0xf bank_mask:0xf
    v_and_b32_dpp v22, v33, v10 row_newbcast:5 row_mask:0xf bank_mask:0xf
    v_and_b32_dpp v23, v33, v11 row_newbcast:5 row_mask:0xf bank_mask:0xf
    s_waitcnt vmcnt(18)
    buffer_load_dwordx4 v[64:67], v42, s[36:39], s53 offen offset:0 nt
    buffer_load_dwordx4 v[68:71], v42, s[36:39], s53 offen offset:256 nt
    v_mfma_f32_16x16x32_bf16 v[24:27], v[16:19], v[80:83], v[24:27]
    v_mfma_f32_16x16x32_bf16 v[24:27], v[20:23], v[84:87], v[24:27]
    v_and_b32_dpp v16, v33, v8 row_newbcast:9 row_mask:0xf bank_mask:0xf
    v_and_b32_dpp v17, v33, v9 row_newbcast:9 row_mask:0xf bank_mask:0xf
    v_and_b32_dpp v18, v33, v10 row_newbcast:9 row_mask:0xf bank_mask:0xf
    v_and_b32_dpp v19, v33, v11 row_newbcast:9 row_mask:0xf bank_mask:0xf
    v_and_b32_dpp v20, v33, v8 row_newbcast:13 row_mask:0xf bank_mask:0xf
    v_and_b32_dpp v21, v33, v9 row_newbcast:13 row_mask:0xf bank_mask:0xf
    v_and_b32_dpp v22, v33, v10 row_newbcast:13 row_mask:0xf bank_mask:0xf
    v_and_b32_dpp v23, v33, v11 row_newbcast:13 row_mask:0xf bank_mask:0xf
    s_waitcnt vmcnt(18)
    buffer_load_dwordx4 v[72:75], v42, s[36:39], s53 offen offset:512 nt
    buffer_load_dwordx4 v[76:79], v42, s[36:39], s53 offen offset:768 nt
    v_mfma_f32_16x16x32_bf16 v[24:27], v[16:19], v[88:91], v[24:27]
    v_mfma_f32_16x16x32_bf16 v[24:27], v[20:23], v[92:95], v[24:27]
    v_and_b32_dpp v16, v33, v8 row_newbcast:2 row_mask:0xf bank_mask:0xf
    v_and_b32_dpp v17, v33, v9 row_newbcast:2 row_mask:0xf bank_mask:0xf
    v_and_b32_dpp v18, v33, v10 row_newbcast:2 row_mask:0xf bank_mask:0xf
    v_and_b32_dpp v19, v33, v11 row_newbcast:2 row_mask:0xf bank_mask:0xf
    v_and_b32_dpp v20, v33, v8 row_newbcast:6 row_mask:0xf bank_mask:0xf
    v_and_b32_dpp v21, v33, v9 row_newbcast:6 row_mask:0xf bank_mask:0xf
    v_and_b32_dpp v22, v33, v10 row_newbcast:6 row_mask:0xf bank_mask:0xf
    v_and_b32_dpp v23, v33, v11 row_newbcast:6 row_mask:0xf bank_mask:0xf
    s_waitcnt vmcnt(18)
    buffer_load_dwordx4 v[80:83], v43, s[36:39], s53 offen offset:0 nt
    buffer_load_dwordx4 v[84:87], v43, s[36:39], s53 offen offset:256 nt
    v_mfma_f32_16x16x32_bf16 v[24:27], v[16:19], v[96:99], v[24:27]
    v_mfma_f32_16x16x32_bf16 v[24:27], v[20:23], v[100:103], v[24:27]
    v_and_b32_dpp v16, v33, v8 row_newbcast:10 row_mask:0xf bank_mask:0xf
    v_and_b32_dpp v17, v33, v9 row_newbcast:10 row_mask:0xf bank_mask:0xf
    v_and_b32_dpp v18, v33, v10 row_newbcast:10 row_mask:0xf bank_mask:0xf
    v_and_b32_dpp v19, v33, v11 row_newbcast:10 row_mask:0xf bank_mask:0xf
    v_and_b32_dpp v20, v33, v8 row_newbcast:14 row_mask:0xf bank_mask:0xf
    v_and_b32_dpp v21, v33, v9 row_newbcast:14 row_mask:0xf bank_mask:0xf
    v_and_b32_dpp v22, v33, v10 row_newbcast:14 row_mask:0xf bank_mask:0xf
    v_and_b32_dpp v23, v33, v11 row_newbcast:14 row_mask:0xf bank_mask:0xf
    s_waitcnt vmcnt(18)
    buffer_load_dwordx4 v[88:91], v43, s[36:39], s53 offen offset:512 nt
    buffer_load_dwordx4 v[92:95], v43, s[36:39], s53 offen offset:768 nt
    s_add_u32 s68, s53, 4096
    s_xor_b32 s69, s68, s53
    s_and_b32 s69, s69, 65536
    s_add_u32 s53, s68, s69
    v_mfma_f32_16x16x32_bf16 v[24:27], v[16:19], v[104:107], v[24:27]
    v_mfma_f32_16x16x32_bf16 v[24:27], v[20:23], v[108:111], v[24:27]
    v_and_b32_dpp v16, v33, v8 row_newbcast:3 row_mask:0xf bank_mask:0xf
    v_and_b32_dpp v17, v33, v9 row_newbcast:3 row_mask:0xf bank_mask:0xf
    v_and_b32_dpp v18, v33, v10 row_newbcast:3 row_mask:0xf bank_mask:0xf
    v_and_b32_dpp v19, v33, v11 row_newbcast:3 row_mask:0xf bank_mask:0xf
    v_and_b32_dpp v20, v33, v8 row_newbcast:7 row_mask:0xf bank_mask:0xf
    v_and_b32_dpp v21, v33, v9 row_newbcast:7 row_mask:0xf bank_mask:0xf
    v_and_b32_dpp v22, v33, v10 row_newbcast:7 row_mask:0xf bank_mask:0xf
    v_and_b32_dpp v23, v33, v11 row_newbcast:7 row_mask:0xf bank_mask:0xf
    s_waitcnt vmcnt(18)
    buffer_load_dwordx4 v[96:99], v42, s[36:39], s53 offen offset:0 nt
    buffer_load_dwordx4 v[100:103], v42, s[36:39], s53 offen offset:256 nt
    v_mfma_f32_16x16x32_bf16 v[24:27], v[16:19], v[112:115], v[24:27]
    v_mfma_f32_16x16x32_bf16 v[24:27], v[20:23], v[116:119], v[24:27]
    v_and_b32_dpp v16, v33, v8 row_newbcast:11 row_mask:0xf bank_mask:0xf
    v_and_b32_dpp v17, v33, v9 row_newbcast:11 row_mask:0xf bank_mask:0xf
    v_and_b32_dpp v18, v33, v10 row_newbcast:11 row_mask:0xf bank_mask:0xf
    v_and_b32_dpp v19, v33, v11 row_newbcast:11 row_mask:0xf bank_mask:0xf
    v_and_b32_dpp v20, v33, v8 row_newbcast:15 row_mask:0xf bank_mask:0xf
    v_and_b32_dpp v21, v33, v9 row_newbcast:15 row_mask:0xf bank_mask:0xf
    v_and_b32_dpp v22, v33, v10 row_newbcast:15 row_mask:0xf bank_mask:0xf
    v_and_b32_dpp v23, v33, v11 row_newbcast:15 row_mask:0xf bank_mask:0xf
    s_waitcnt vmcnt(18)
    buffer_load_dwordx4 v[104:107], v42, s[36:39], s53 offen offset:512 nt
    buffer_load_dwordx4 v[108:111], v42, s[36:39], s53 offen offset:768 nt
    v_mfma_f32_16x16x32_bf16 v[24:27], v[16:19], v[120:123], v[24:27]
    v_mfma_f32_16x16x32_bf16 v[24:27], v[20:23], v[124:127], v[24:27]
    s_waitcnt lgkmcnt(0)
    v_fma_f32 v31, v30, s55, -v35
    v_exp_f32 v31, v31
    v_add_u32 v38, 512, v38
    ds_read_b32 v30, v38 offset:0
    v_cvt_pk_bf16_f32 v33, v31, v31
    v_add_f32 v36, v36, v31
    s_nop 0
    v_and_b32_dpp v16, v33, v8 row_newbcast:0 row_mask:0xf bank_mask:0xf
    v_and_b32_dpp v17, v33, v9 row_newbcast:0 row_mask:0xf bank_mask:0xf
    v_and_b32_dpp v18, v33, v10 row_newbcast:0 row_mask:0xf bank_mask:0xf
    v_and_b32_dpp v19, v33, v11 row_newbcast:0 row_mask:0xf bank_mask:0xf
    v_and_b32_dpp v20, v33, v8 row_newbcast:4 row_mask:0xf bank_mask:0xf
    v_and_b32_dpp v21, v33, v9 row_newbcast:4 row_mask:0xf bank_mask:0xf
    v_and_b32_dpp v22, v33, v10 row_newbcast:4 row_mask:0xf bank_mask:0xf
    v_and_b32_dpp v23, v33, v11 row_newbcast:4 row_mask:0xf bank_mask:0xf
    s_waitcnt vmcnt(18)
    buffer_load_dwordx4 v[112:115], v43, s[36:39], s53 offen offset:0 nt
    buffer_load_dwordx4 v[116:119], v43, s[36:39], s53 offen offset:256 nt
    v_mfma_f32_16x16x32_bf16 v[24:27], v[16:19], v[128:131], v[24:27]
    v_mfma_f32_16x16x32_bf16 v[24:27], v[20:23], v[132:135], v[24:27]
    v_and_b32_dpp v16, v33, v8 row_newbcast:8 row_mask:0xf bank_mask:0xf
    v_and_b32_dpp v17, v33, v9 row_newbcast:8 row_mask:0xf bank_mask:0xf
    v_and_b32_dpp v18, v33, v10 row_newbcast:8 row_mask:0xf bank_mask:0xf
    v_and_b32_dpp v19, v33, v11 row_newbcast:8 row_mask:0xf bank_mask:0xf
    v_and_b32_dpp v20, v33, v8 row_newbcast:12 row_mask:0xf bank_mask:0xf
    v_and_b32_dpp v21, v33, v9 row_newbcast:12 row_mask:0xf bank_mask:0xf
    v_and_b32_dpp v22, v33, v10 row_newbcast:12 row_mask:0xf bank_mask:0xf
    v_and_b32_dpp v23, v33, v11 row_newbcast:12 row_mask:0xf bank_mask:0xf
    s_waitcnt vmcnt(18)
    buffer_load_dwordx4 v[120:123], v43, s[36:39], s53 offen offset:512 nt
    buffer_load_dwordx4 v[124:127], v43, s[36:39], s53 offen offset:768 nt
    s_add_u32 s68, s53, 4096
    s_xor_b32 s69, s68, s53
    s_and_b32 s69, s69, 65536
    s_add_u32 s53, s68, s69
    v_mfma_f32_16x16x32_bf16 v[24:27], v[16:19], v[136:139], v[24:27]
    v_mfma_f32_16x16x32_bf16 v[24:27], v[20:23], v[140:143], v[24:27]
    v_and_b32_dpp v16, v33, v8 row_newbcast:1 row_mask:0xf bank_mask:0xf
    v_and_b32_dpp v17, v33, v9 row_newbcast:1 row_mask:0xf bank_mask:0xf
    v_and_b32_dpp v18, v33, v10 row_newbcast:1 row_mask:0xf bank_mask:0xf
    v_and_b32_dpp v19, v33, v11 row_newbcast:1 row_mask:0xf bank_mask:0xf
    v_and_b32_dpp v20, v33, v8 row_newbcast:5 row_mask:0xf bank_mask:0xf
    v_and_b32_dpp v21, v33, v9 row_newbcast:5 row_mask:0xf bank_mask:0xf
    v_and_b32_dpp v22, v33, v10 row_newbcast:5 row_mask:0xf bank_mask:0xf
    v_and_b32_dpp v23, v33, v11 row_newbcast:5 row_mask:0xf bank_mask:0xf
    s_waitcnt vmcnt(18)
    buffer_load_dwordx4 v[128:131], v42, s[36:39], s53 offen offset:0 nt
    buffer_load_dwordx4 v[132:135], v42, s[36:39], s53 offen offset:256 nt
    v_mfma_f32_16x16x32_bf16 v[24:27], v[16:19], v[144:147], v[24:27]
    v_mfma_f32_16x16x32_bf16 v[24:27], v[20:23], v[148:151], v[24:27]
    v_and_b32_dpp v16, v33, v8 row_newbcast:9 row_mask:0xf bank_mask:0xf
    v_and_b32_dpp v17, v33, v9 row_newbcast:9 row_mask:0xf bank_mask:0xf
    v_and_b32_dpp v18, v33, v10 row_newbcast:9 row_mask:0xf bank_mask:0xf
    v_and_b32_dpp v19, v33, v11 row_newbcast:9 row_mask:0xf bank_mask:0xf
    v_and_b32_dpp v20, v33, v8 row_newbcast:13 row_mask:0xf bank_mask:0xf
    v_and_b32_dpp v21, v33, v9 row_newbcast:13 row_mask:0xf bank_mask:0xf
    v_and_b32_dpp v22, v33, v10 row_newbcast:13 row_mask:0xf bank_mask:0xf
    v_and_b32_dpp v23, v33, v11 row_newbcast:13 row_mask:0xf bank_mask:0xf
    s_waitcnt vmcnt(18)
    buffer_load_dwordx4 v[136:139], v42, s[36:39], s53 offen offset:512 nt
    buffer_load_dwordx4 v[140:143], v42, s[36:39], s53 offen offset:768 nt
    v_mfma_f32_16x16x32_bf16 v[24:27], v[16:19], v[152:155], v[24:27]
    v_mfma_f32_16x16x32_bf16 v[24:27], v[20:23], v[156:159], v[24:27]
    v_and_b32_dpp v16, v33, v8 row_newbcast:2 row_mask:0xf bank_mask:0xf
    v_and_b32_dpp v17, v33, v9 row_newbcast:2 row_mask:0xf bank_mask:0xf
    v_and_b32_dpp v18, v33, v10 row_newbcast:2 row_mask:0xf bank_mask:0xf
    v_and_b32_dpp v19, v33, v11 row_newbcast:2 row_mask:0xf bank_mask:0xf
    v_and_b32_dpp v20, v33, v8 row_newbcast:6 row_mask:0xf bank_mask:0xf
    v_and_b32_dpp v21, v33, v9 row_newbcast:6 row_mask:0xf bank_mask:0xf
    v_and_b32_dpp v22, v33, v10 row_newbcast:6 row_mask:0xf bank_mask:0xf
    v_and_b32_dpp v23, v33, v11 row_newbcast:6 row_mask:0xf bank_mask:0xf
    s_waitcnt vmcnt(18)
    buffer_load_dwordx4 v[144:147], v43, s[36:39], s53 offen offset:0 nt
    buffer_load_dwordx4 v[148:151], v43, s[36:39], s53 offen offset:256 nt
    v_mfma_f32_16x16x32_bf16 v[24:27], v[16:19], v[160:163], v[24:27]
    v_mfma_f32_16x16x32_bf16 v[24:27], v[20:23], v[164:167], v[24:27]
    v_and_b32_dpp v16, v33, v8 row_newbcast:10 row_mask:0xf bank_mask:0xf
    v_and_b32_dpp v17, v33, v9 row_newbcast:10 row_mask:0xf bank_mask:0xf
    v_and_b32_dpp v18, v33, v10 row_newbcast:10 row_mask:0xf bank_mask:0xf
    v_and_b32_dpp v19, v33, v11 row_newbcast:10 row_mask:0xf bank_mask:0xf
    v_and_b32_dpp v20, v33, v8 row_newbcast:14 row_mask:0xf bank_mask:0xf
    v_and_b32_dpp v21, v33, v9 row_newbcast:14 row_mask:0xf bank_mask:0xf
    v_and_b32_dpp v22, v33, v10 row_newbcast:14 row_mask:0xf bank_mask:0xf
    v_and_b32_dpp v23, v33, v11 row_newbcast:14 row_mask:0xf bank_mask:0xf
    s_waitcnt vmcnt(18)
    buffer_load_dwordx4 v[152:155], v43, s[36:39], s53 offen offset:512 nt
    buffer_load_dwordx4 v[156:159], v43, s[36:39], s53 offen offset:768 nt
    s_add_u32 s68, s53, 4096
    s_xor_b32 s69, s68, s53
    s_and_b32 s69, s69, 65536
    s_add_u32 s53, s68, s69
    v_mfma_f32_16x16x32_bf16 v[24:27], v[16:19], v[168:171], v[24:27]
    v_mfma_f32_16x16x32_bf16 v[24:27], v[20:23], v[172:175], v[24:27]
    v_and_b32_dpp v16, v33, v8 row_newbcast:3 row_mask:0xf bank_mask:0xf
    v_and_b32_dpp v17, v33, v9 row_newbcast:3 row_mask:0xf bank_mask:0xf
    v_and_b32_dpp v18, v33, v10 row_newbcast:3 row_mask:0xf bank_mask:0xf
    v_and_b32_dpp v19, v33, v11 row_newbcast:3 row_mask:0xf bank_mask:0xf
    v_and_b32_dpp v20, v33, v8 row_newbcast:7 row_mask:0xf bank_mask:0xf
    v_and_b32_dpp v21, v33, v9 row_newbcast:7 row_mask:0xf bank_mask:0xf
    v_and_b32_dpp v22, v33, v10 row_newbcast:7 row_mask:0xf bank_mask:0xf
    v_and_b32_dpp v23, v33, v11 row_newbcast:7 row_mask:0xf bank_mask:0xf
    s_waitcnt vmcnt(18)
    buffer_load_dwordx4 v[160:163], v42, s[36:39], s53 offen offset:0 nt
    buffer_load_dwordx4 v[164:167], v42, s[36:39], s53 offen offset:256 nt
    v_mfma_f32_16x16x32_bf16 v[24:27], v[16:19], v[176:179], v[24:27]
    v_mfma_f32_16x16x32_bf16 v[24:27], v[20:23], v[180:183], v[24:27]
    v_and_b32_dpp v16, v33, v8 row_newbcast:11 row_mask:0xf bank_mask:0xf
    v_and_b32_dpp v17, v33, v9 row_newbcast:11 row_mask:0xf bank_mask:0xf
    v_and_b32_dpp v18, v33, v10 row_newbcast:11 row_mask:0xf bank_mask:0xf
    v_and_b32_dpp v19, v33, v11 row_newbcast:11 row_mask:0xf bank_mask:0xf
    v_and_b32_dpp v20, v33, v8 row_newbcast:15 row_mask:0xf bank_mask:0xf
    v_and_b32_dpp v21, v33, v9 row_newbcast:15 row_mask:0xf bank_mask:0xf
    v_and_b32_dpp v22, v33, v10 row_newbcast:15 row_mask:0xf bank_mask:0xf
    v_and_b32_dpp v23, v33, v11 row_newbcast:15 row_mask:0xf bank_mask:0xf
    s_waitcnt vmcnt(18)
    buffer_load_dwordx4 v[168:171], v42, s[36:39], s53 offen offset:512 nt
    buffer_load_dwordx4 v[172:175], v42, s[36:39], s53 offen offset:768 nt
    v_mfma_f32_16x16x32_bf16 v[24:27], v[16:19], v[184:187], v[24:27]
    v_mfma_f32_16x16x32_bf16 v[24:27], v[20:23], v[188:191], v[24:27]
    s_waitcnt lgkmcnt(0)
    v_fma_f32 v31, v30, s55, -v35
    v_exp_f32 v31, v31
    ds_read_b32 v30, v38 offset:256
    v_cvt_pk_bf16_f32 v33, v31, v31
    v_add_f32 v36, v36, v31
    s_nop 0
    v_and_b32_dpp v16, v33, v8 row_newbcast:0 row_mask:0xf bank_mask:0xf
    v_and_b32_dpp v17, v33, v9 row_newbcast:0 row_mask:0xf bank_mask:0xf
    v_and_b32_dpp v18, v33, v10 row_newbcast:0 row_mask:0xf bank_mask:0xf
    v_and_b32_dpp v19, v33, v11 row_newbcast:0 row_mask:0xf bank_mask:0xf
    v_and_b32_dpp v20, v33, v8 row_newbcast:4 row_mask:0xf bank_mask:0xf
    v_and_b32_dpp v21, v33, v9 row_newbcast:4 row_mask:0xf bank_mask:0xf
    v_and_b32_dpp v22, v33, v10 row_newbcast:4 row_mask:0xf bank_mask:0xf
    v_and_b32_dpp v23, v33, v11 row_newbcast:4 row_mask:0xf bank_mask:0xf
L_Vdisp:
    s_sub_u32 s58, s58, 1
    s_cmp_eq_u32 s58, s74
    s_cbranch_scc1 L_midB
L_midBback:
    v_readfirstlane_b32 s60, v32
    s_cmp_eq_u32 s58, 0
    s_cbranch_scc1 L_Vexit
    s_lshr_b32 s61, s60, 2
    s_cmp_gt_u32 s58, s61
    s_cselect_b32 s60, s60, 0
    s_bitcmp1_b32 s60, 0
    s_cbranch_scc1 L_loopVf
    s_bitcmp1_b32 s60, 1
    s_cbranch_scc1 L_loopVs
    s_branch L_loopV
L_Vexit:
    s_waitcnt vmcnt(18)
    buffer_load_dwordx4 v[176:179], v43, s[36:39], s53 offen offset:0 nt
    buffer_load_dwordx4 v[180:183], v43, s[36:39], s53 offen offset:256 nt
    v_mfma_f32_16x16x32_bf16 v[24:27], v[16:19], v[64:67], v[24:27]
    v_mfma_f32_16x16x32_bf16 v[24:27], v[20:23], v[68:71], v[24:27]
    v_and_b32_dpp v16, v33, v8 row_newbcast:8 row_mask:0xf bank_mask:0xf
    v_and_b32_dpp v17, v33, v9 row_newbcast:8 row_mask:0xf bank_mask:0xf
    v_and_b32_dpp v18, v33, v10 row_newbcast:8 row_mask:0xf bank_mask:0xf
    v_and_b32_dpp v19, v33, v11 row_newbcast:8 row_mask:0xf bank_mask:0xf
    v_and_b32_dpp v20, v33, v8 row_newbcast:12 row_mask:0xf bank_mask:0xf
    v_and_b32_dpp v21, v33, v9 row_newbcast:12 row_mask:0xf bank_mask:0xf
    v_and_b32_dpp v22, v33, v10 row_newbcast:12 row_mask:0xf bank_mask:0xf
    v_and_b32_dpp v23, v33, v11 row_newbcast:12 row_mask:0xf bank_mask:0xf
    s_waitcnt vmcnt(18)
    buffer_load_dwordx4 v[184:187], v43, s[36:39], s53 offen offset:512 nt
    buffer_load_dwordx4 v[188:191], v43, s[36:39], s53 offen offset:768 nt
    s_add_u32 s68, s53, 4096
    s_xor_b32 s69, s68, s53
    s_and_b32 s69, s69, 65536
    s_add_u32 s53, s68, s69
    v_mfma_f32_16x16x32_bf16 v[24:27], v[16:19], v[72:75], v[24:27]
    v_mfma_f32_16x16x32_bf16 v[24:27], v[20:23], v[76:79], v[24:27]
    v_and_b32_dpp v16, v33, v8 row_newbcast:1 row_mask:0xf bank_mask:0xf
    v_and_b32_dpp v17, v33, v9 row_newbcast:1 row_mask:0xf bank_mask:0xf
    v_and_b32_dpp v18, v33, v10 row_newbcast:1 row_mask:0xf bank_mask:0xf
    v_and_b32_dpp v19, v33, v11 row_newbcast:1 row_mask:0xf bank_mask:0xf
    v_and_b32_dpp v20, v33, v8 row_newbcast:5 row_mask:0xf bank_mask:0xf
    v_and_b32_dpp v21, v33, v9 row_newbcast:5 row_mask:0xf bank_mask:0xf
    v_and_b32_dpp v22, v33, v10 row_newbcast:5 row_mask:0xf bank_mask:0xf
    v_and_b32_dpp v23, v33, v11 row_newbcast:5 row_mask:0xf bank_mask:0xf
    s_waitcnt vmcnt(18)
    buffer_load_dwordx4 v[64:67], v42, s[36:39], s53 offen offset:0 nt
    buffer_load_dwordx4 v[68:71], v42, s[36:39], s53 offen offset:256 nt
    v_mfma_f32_16x16x32_bf16 v[24:27], v[16:19], v[80:83], v[24:27]
    v_mfma_f32_16x16x32_bf16 v[24:27], v[20:23], v[84:87], v[24:27]
    v_and_b32_dpp v16, v33, v8 row_newbcast:9 row_mask:0xf bank_mask:0xf
    v_and_b32_dpp v17, v33, v9 row_newbcast:9 row_mask:0xf bank_mask:0xf
    v_and_b32_dpp v18, v33, v10 row_newbcast:9 row_mask:0xf bank_mask:0xf
    v_and_b32_dpp v19, v33, v11 row_newbcast:9 row_mask:0xf bank_mask:0xf
    v_and_b32_dpp v20, v33, v8 row_newbcast:13 row_mask:0xf bank_mask:0xf
    v_and_b32_dpp v21, v33, v9 row_newbcast:13 row_mask:0xf bank_mask:0xf
    v_and_b32_dpp v22, v33, v10 row_newbcast:13 row_mask:0xf bank_mask:0xf
    v_and_b32_dpp v23, v33, v11 row_newbcast:13 row_mask:0xf bank_mask:0xf
    s_waitcnt vmcnt(18)
    buffer_load_dwordx4 v[72:75], v42, s[36:39], s53 offen offset:512 nt
    buffer_load_dwordx4 v[76:79], v42, s[36:39], s53 offen offset:768 nt
    v_mfma_f32_16x16x32_bf16 v[24:27], v[16:19], v[88:91], v[24:27]
    v_mfma_f32_16x16x32_bf16 v[24:27], v[20:23], v[92:95], v[24:27]
    v_and_b32_dpp v16, v33, v8 row_newbcast:2 row_mask:0xf bank_mask:0xf
    v_and_b32_dpp v17, v33, v9 row_newbcast:2 row_mask:0xf bank_mask:0xf
    v_and_b32_dpp v18, v33, v10 row_newbcast:2 row_mask:0xf bank_mask:0xf
    v_and_b32_dpp v19, v33, v11 row_newbcast:2 row_mask:0xf bank_mask:0xf
    v_and_b32_dpp v20, v33, v8 row_newbcast:6 row_mask:0xf bank_mask:0xf
    v_and_b32_dpp v21, v33, v9 row_newbcast:6 row_mask:0xf bank_mask:0xf
    v_and_b32_dpp v22, v33, v10 row_newbcast:6 row_mask:0xf bank_mask:0xf
    v_and_b32_dpp v23, v33, v11 row_newbcast:6 row_mask:0xf bank_mask:0xf
    s_waitcnt vmcnt(18)
    buffer_load_dwordx4 v[80:83], v43, s[36:39], s53 offen offset:0 nt
    buffer_load_dwordx4 v[84:87], v43, s[36:39], s53 offen offset:256 nt
    v_mfma_f32_16x16x32_bf16 v[24:27], v[16:19], v[96:99], v[24:27]
    v_mfma_f32_16x16x32_bf16 v[24:27], v[20:23], v[100:103], v[24:27]
    v_and_b32_dpp v16, v33, v8 row_newbcast:10 row_mask:0xf bank_mask:0xf
    v_and_b32_dpp v17, v33, v9 row_newbcast:10 row_mask:0xf bank_mask:0xf
    v_and_b32_dpp v18, v33, v10 row_newbcast:10 row_mask:0xf bank_mask:0xf
    v_and_b32_dpp v19, v33, v11 row_newbcast:10 row_mask:0xf bank_mask:0xf
    v_and_b32_dpp v20, v33, v8 row_newbcast:14 row_mask:0xf bank_mask:0xf
    v_and_b32_dpp v21, v33, v9 row_newbcast:14 row_mask:0xf bank_mask:0xf
    v_and_b32_dpp v22, v33, v10 row_newbcast:14 row_mask:0xf bank_mask:0xf
    v_and_b32_dpp v23, v33, v11 row_newbcast:14 row_mask:0xf bank_mask:0xf
    s_waitcnt vmcnt(18)
    buffer_load_dwordx4 v[88:91], v43, s[36:39], s53 offen offset:512 nt
    buffer_load_dwordx4 v[92:95], v43, s[36:39], s53 offen offset:768 nt
    s_add_u32 s68, s53, 4096
    s_xor_b32 s69, s68, s53
    s_and_b32 s69, s69, 65536
    s_add_u32 s53, s68, s69
    v_mfma_f32_16x16x32_bf16 v[24:27], v[16:19], v[104:107], v[24:27]
    v_mfma_f32_16x16x32_bf16 v[24:27], v[20:23], v[108:111], v[24:27]
    v_and_b32_dpp v16, v33, v8 row_newbcast:3 row_mask:0xf bank_mask:0xf
    v_and_b32_dpp v17, v33, v9 row_newbcast:3 row_mask:0xf bank_mask:0xf
    v_and_b32_dpp v18, v33, v10 row_newbcast:3 row_mask:0xf bank_mask:0xf
    v_and_b32_dpp v19, v33, v11 row_newbcast:3 row_mask:0xf bank_mask:0xf
    v_and_b32_dpp v20, v33, v8 row_newbcast:7 row_mask:0xf bank_mask:0xf
    v_and_b32_dpp v21, v33, v9 row_newbcast:7 row_mask:0xf bank_mask:0xf
    v_and_b32_dpp v22, v33, v10 row_newbcast:7 row_mask:0xf bank_mask:0xf
    v_and_b32_dpp v23, v33, v11 row_newbcast:7 row_mask:0xf bank_mask:0xf
    s_waitcnt vmcnt(18)
    buffer_load_dwordx4 v[96:99], v42, s[36:39], s53 offen offset:0 nt
    buffer_load_dwordx4 v[100:103], v42, s[36:39], s53 offen offset:256 nt
    v_mfma_f32_16x16x32_bf16 v[24:27], v[16:19], v[112:115], v[24:27]
    v_mfma_f32_16x16x32_bf16 v[24:27], v[20:23], v[116:119], v[24:27]
    v_and_b32_dpp v16, v33, v8 row_newbcast:11 row_mask:0xf bank_mask:0xf
    v_and_b32_dpp v17, v33, v9 row_newbcast:11 row_mask:0xf bank_mask:0xf
    v_and_b32_dpp v18, v33, v10 row_newbcast:11 row_mask:0xf bank_mask:0xf
    v_and_b32_dpp v19, v33, v11 row_newbcast:11 row_mask:0xf bank_mask:0xf
    v_and_b32_dpp v20, v33, v8 row_newbcast:15 row_mask:0xf bank_mask:0xf
    v_and_b32_dpp v21, v33, v9 row_newbcast:15 row_mask:0xf bank_mask:0xf
    v_and_b32_dpp v22, v33, v10 row_newbcast:15 row_mask:0xf bank_mask:0xf
    v_and_b32_dpp v23, v33, v11 row_newbcast:15 row_mask:0xf bank_mask:0xf
    s_waitcnt vmcnt(18)
    buffer_load_dwordx4 v[104:107], v42, s[36:39], s53 offen offset:512 nt
    buffer_load_dwordx4 v[108:111], v42, s[36:39], s53 offen offset:768 nt
    v_mfma_f32_16x16x32_bf16 v[24:27], v[16:19], v[120:123], v[24:27]
    v_mfma_f32_16x16x32_bf16 v[24:27], v[20:23], v[124:127], v[24:27]
    s_waitcnt lgkmcnt(0)
    v_fma_f32 v31, v30, s55, -v35
    v_exp_f32 v31, v31
    v_add_u32 v38, 512, v38
    ds_read_b32 v30, v38 offset:0
    v_cvt_pk_bf16_f32 v33, v31, v31
    v_add_f32 v36, v36, v31
    s_nop 0
    v_and_b32_dpp v16, v33, v8 row_newbcast:0 row_mask:0xf bank_mask:0xf
    v_and_b32_dpp v17, v33, v9 row_newbcast:0 row_mask:0xf bank_mask:0xf
    v_and_b32_dpp v18, v33, v10 row_newbcast:0 row_mask:0xf bank_mask:0xf
    v_and_b32_dpp v19, v33, v11 row_newbcast:0 row_mask:0xf bank_mask:0xf
    v_and_b32_dpp v20, v33, v8 row_newbcast:4 row_mask:0xf bank_mask:0xf
    v_and_b32_dpp v21, v33, v9 row_newbcast:4 row_mask:0xf bank_mask:0xf
    v_and_b32_dpp v22, v33, v10 row_newbcast:4 row_mask:0xf bank_mask:0xf
    v_and_b32_dpp v23, v33, v11 row_newbcast:4 row_mask:0xf bank_mask:0xf
    s_waitcnt vmcnt(18)
    buffer_load_dwordx4 v[112:115], v43, s[36:39], s53 offen offset:0 nt
    buffer_load_dwordx4 v[116:119], v43, s[36:39], s53 offen offset:256 nt
    v_mfma_f32_16x16x32_bf16 v[24:27], v[16:19], v[128:131], v[24:27]
    v_mfma_f32_16x16x32_bf16 v[24:27], v[20:23], v[132:135], v[24:27]
    v_and_b32_dpp v16, v33, v8 row_newbcast:8 row_mask:0xf bank_mask:0xf
    v_and_b32_dpp v17, v33, v9 row_newbcast:8 row_mask:0xf bank_mask:0xf
    v_and_b32_dpp v18, v33, v10 row_newbcast:8 row_mask:0xf bank_mask:0xf
    v_and_b32_dpp v19, v33, v11 row_newbcast:8 row_mask:0xf bank_mask:0xf
    v_and_b32_dpp v20, v33, v8 row_newbcast:12 row_mask:0xf bank_mask:0xf
    v_and_b32_dpp v21, v33, v9 row_newbcast:12 row_mask:0xf bank_mask:0xf
    v_and_b32_dpp v22, v33, v10 row_newbcast:12 row_mask:0xf bank_mask:0xf
    v_and_b32_dpp v23, v33, v11 row_newbcast:12 row_mask:0xf bank_mask:0xf
    s_waitcnt vmcnt(18)
    buffer_load_dwordx4 v[120:123], v43, s[36:39], s53 offen offset:512 nt
    buffer_load_dwordx4 v[124:127], v43, s[36:39], s53 offen offset:768 nt
    s_add_u32 s68, s53, 4096
    s_xor_b32 s69, s68, s53
    s_and_b32 s69, s69, 65536
    s_add_u32 s53, s68, s69
    v_mfma_f32_16x16x32_bf16 v[24:27], v[16:19], v[136:139], v[24:27]
    v_mfma_f32_16x16x32_bf16 v[24:27], v[20:23], v[140:143], v[24:27]
    v_and_b32_dpp v16, v33, v8 row_newbcast:1 row_mask:0xf bank_mask:0xf
    v_and_b32_dpp v17, v33, v9 row_newbcast:1 row_mask:0xf bank_mask:0xf
    v_and_b32_dpp v18, v33, v10 row_newbcast:1 row_mask:0xf bank_mask:0xf
    v_and_b32_dpp v19, v33, v11 row_newbcast:1 row_mask:0xf bank_mask:0xf
    v_and_b32_dpp v20, v33, v8 row_newbcast:5 row_mask:0xf bank_mask:0xf
    v_and_b32_dpp v21, v33, v9 row_newbcast:5 row_mask:0xf bank_mask:0xf
    v_and_b32_dpp v22, v33, v10 row_newbcast:5 row_mask:0xf bank_mask:0xf
    v_and_b32_dpp v23, v33, v11 row_newbcast:5 row_mask:0xf bank_mask:0xf
    s_waitcnt vmcnt(18)
    buffer_load_dwordx4 v[128:131], v42, s[36:39], s53 offen offset:0 nt
    buffer_load_dwordx4 v[132:135], v42, s[36:39], s53 offen offset:256 nt
    v_mfma_f32_16x16x32_bf16 v[24:27], v[16:19], v[144:147], v[24:27]
    v_mfma_f32_16x16x32_bf16 v[24:27], v[20:23], v[148:151], v[24:27]
    v_and_b32_dpp v16, v33, v8 row_newbcast:9 row_mask:0xf bank_mask:0xf
    v_and_b32_dpp v17, v33, v9 row_newbcast:9 row_mask:0xf bank_mask:0xf
    v_and_b32_dpp v18, v33, v10 row_newbcast:9 row_mask:0xf bank_mask:0xf
    v_and_b32_dpp v19, v33, v11 row_newbcast:9 row_mask:0xf bank_mask:0xf
    v_and_b32_dpp v20, v33, v8 row_newbcast:13 row_mask:0xf bank_mask:0xf
    v_and_b32_dpp v21, v33, v9 row_newbcast:13 row_mask:0xf bank_mask:0xf
    v_and_b32_dpp v22, v33, v10 row_newbcast:13 row_mask:0xf bank_mask:0xf
    v_and_b32_dpp v23, v33, v11 row_newbcast:13 row_mask:0xf bank_mask:0xf
    s_waitcnt vmcnt(18)
    buffer_load_dwordx4 v[136:139], v42, s[36:39], s53 offen offset:512 nt
    buffer_load_dwordx4 v[140:143], v42, s[36:39], s53 offen offset:768 nt
    v_mfma_f32_16x16x32_bf16 v[24:27], v[16:19], v[152:155], v[24:27]
    v_mfma_f32_16x16x32_bf16 v[24:27], v[20:23], v[156:159], v[24:27]
    v_and_b32_dpp v16, v33, v8 row_newbcast:2 row_mask:0xf bank_mask:0xf
    v_and_b32_dpp v17, v33, v9 row_newbcast:2 row_mask:0xf bank_mask:0xf
    v_and_b32_dpp v18, v33, v10 row_newbcast:2 row_mask:0xf bank_mask:0xf
    v_and_b32_dpp v19, v33, v11 row_newbcast:2 row_mask:0xf bank_mask:0xf
    v_and_b32_dpp v20, v33, v8 row_newbcast:6 row_mask:0xf bank_mask:0xf
    v_and_b32_dpp v21, v33, v9 row_newbcast:6 row_mask:0xf bank_mask:0xf
    v_and_b32_dpp v22, v33, v10 row_newbcast:6 row_mask:0xf bank_mask:0xf
    v_and_b32_dpp v23, v33, v11 row_newbcast:6 row_mask:0xf bank_mask:0xf
    s_waitcnt vmcnt(18)
    buffer_load_dwordx4 v[144:147], v43, s[36:39], s53 offen offset:0 nt
    buffer_load_dwordx4 v[148:151], v43, s[36:39], s53 offen offset:256 nt
    v_mfma_f32_16x16x32_bf16 v[24:27], v[16:19], v[160:163], v[24:27]
    v_mfma_f32_16x16x32_bf16 v[24:27], v[20:23], v[164:167], v[24:27]
    v_and_b32_dpp v16, v33, v8 row_newbcast:10 row_mask:0xf bank_mask:0xf
    v_and_b32_dpp v17, v33, v9 row_newbcast:10 row_mask:0xf bank_mask:0xf
    v_and_b32_dpp v18, v33, v10 row_newbcast:10 row_mask:0xf bank_mask:0xf
    v_and_b32_dpp v19, v33, v11 row_newbcast:10 row_mask:0xf bank_mask:0xf
    v_and_b32_dpp v20, v33, v8 row_newbcast:14 row_mask:0xf bank_mask:0xf
    v_and_b32_dpp v21, v33, v9 row_newbcast:14 row_mask:0xf bank_mask:0xf
    v_and_b32_dpp v22, v33, v10 row_newbcast:14 row_mask:0xf bank_mask:0xf
    v_and_b32_dpp v23, v33, v11 row_newbcast:14 row_mask:0xf bank_mask:0xf
    s_waitcnt vmcnt(18)
    buffer_load_dwordx4 v[152:155], v43, s[36:39], s53 offen offset:512 nt
    buffer_load_dwordx4 v[156:159], v43, s[36:39], s53 offen offset:768 nt
    s_add_u32 s68, s53, 4096
    s_xor_b32 s69, s68, s53
    s_and_b32 s69, s69, 65536
    s_add_u32 s53, s68, s69
    v_mfma_f32_16x16x32_bf16 v[24:27], v[16:19], v[168:171], v[24:27]
    v_mfma_f32_16x16x32_bf16 v[24:27], v[20:23], v[172:175], v[24:27]
    v_and_b32_dpp v16, v33, v8 row_newbcast:3 row_mask:0xf bank_mask:0xf
    v_and_b32_dpp v17, v33, v9 row_newbcast:3 row_mask:0xf bank_mask:0xf
    v_and_b32_dpp v18, v33, v10 row_newbcast:3 row_mask:0xf bank_mask:0xf
    v_and_b32_dpp v19, v33, v11 row_newbcast:3 row_mask:0xf bank_mask:0xf
    v_and_b32_dpp v20, v33, v8 row_newbcast:7 row_mask:0xf bank_mask:0xf
    v_and_b32_dpp v21, v33, v9 row_newbcast:7 row_mask:0xf bank_mask:0xf
    v_and_b32_dpp v22, v33, v10 row_newbcast:7 row_mask:0xf bank_mask:0xf
    v_and_b32_dpp v23, v33, v11 row_newbcast:7 row_mask:0xf bank_mask:0xf
    s_waitcnt vmcnt(18)
    buffer_load_dwordx4 v[160:163], v42, s[36:39], s53 offen offset:0 nt
    buffer_load_dwordx4 v[164:167], v42, s[36:39], s53 offen offset:256 nt
    v_mfma_f32_16x16x32_bf16 v[24:27], v[16:19], v[176:179], v[24:27]
    v_mfma_f32_16x16x32_bf16 v[24:27], v[20:23], v[180:183], v[24:27]
    v_and_b32_dpp v16, v33, v8 row_newbcast:11 row_mask:0xf bank_mask:0xf
    v_and_b32_dpp v17, v33, v9 row_newbcast:11 row_mask:0xf bank_mask:0xf
    v_and_b32_dpp v18, v33, v10 row_newbcast:11 row_mask:0xf bank_mask:0xf
    v_and_b32_dpp v19, v33, v11 row_newbcast:11 row_mask:0xf bank_mask:0xf
    v_and_b32_dpp v20, v33, v8 row_newbcast:15 row_mask:0xf bank_mask:0xf
    v_and_b32_dpp v21, v33, v9 row_newbcast:15 row_mask:0xf bank_mask:0xf
    v_and_b32_dpp v22, v33, v10 row_newbcast:15 row_mask:0xf bank_mask:0xf
    v_and_b32_dpp v23, v33, v11 row_newbcast:15 row_mask:0xf bank_mask:0xf
    s_waitcnt vmcnt(18)
    buffer_load_dwordx4 v[168:171], v42, s[36:39], s53 offen offset:512 nt
    buffer_load_dwordx4 v[172:175], v42, s[36:39], s53 offen offset:768 nt
    v_mfma_f32_16x16x32_bf16 v[24:27], v[16:19], v[184:187], v[24:27]
    v_mfma_f32_16x16x32_bf16 v[24:27], v[20:23], v[188:191], v[24:27]
    s_waitcnt lgkmcnt(0)
    v_fma_f32 v31, v30, s55, -v35
    v_exp_f32 v31, v31
    ds_read_b32 v30, v38 offset:256
    v_cvt_pk_bf16_f32 v33, v31, v31
    v_add_f32 v36, v36, v31
    s_nop 0
    v_and_b32_dpp v16, v33, v8 row_newbcast:0 row_mask:0xf bank_mask:0xf
    v_and_b32_dpp v17, v33, v9 row_newbcast:0 row_mask:0xf bank_mask:0xf
    v_and_b32_dpp v18, v33, v10 row_newbcast:0 row_mask:0xf bank_mask:0xf
    v_and_b32_dpp v19, v33, v11 row_newbcast:0 row_mask:0xf bank_mask:0xf
    v_and_b32_dpp v20, v33, v8 row_newbcast:4 row_mask:0xf bank_mask:0xf
    v_and_b32_dpp v21, v33, v9 row_newbcast:4 row_mask:0xf bank_mask:0xf
    v_and_b32_dpp v22, v33, v10 row_newbcast:4 row_mask:0xf bank_mask:0xf
    v_and_b32_dpp v23, v33, v11 row_newbcast:4 row_mask:0xf bank_mask:0xf
    s_waitcnt vmcnt(18)
    buffer_load_dwordx4 v[176:179], v43, s[36:39], s53 offen offset:0 nt
    buffer_load_dwordx4 v[180:183], v43, s[36:39], s53 offen offset:256 nt
    v_mfma_f32_16x16x32_bf16 v[24:27], v[16:19], v[64:67], v[24:27]
    v_mfma_f32_16x16x32_bf16 v[24:27], v[20:23], v[68:71], v[24:27]
    v_and_b32_dpp v16, v33, v8 row_newbcast:8 row_mask:0xf bank_mask:0xf
    v_and_b32_dpp v17, v33, v9 row_newbcast:8 row_mask:0xf bank_mask:0xf
    v_and_b32_dpp v18, v33, v10 row_newbcast:8 row_mask:0xf bank_mask:0xf
    v_and_b32_dpp v19, v33, v11 row_newbcast:8 row_mask:0xf bank_mask:0xf
    v_and_b32_dpp v20, v33, v8 row_newbcast:12 row_mask:0xf bank_mask:0xf
    v_and_b32_dpp v21, v33, v9 row_newbcast:12 row_mask:0xf bank_mask:0xf
    v_and_b32_dpp v22, v33, v10 row_newbcast:12 row_mask:0xf bank_mask:0xf
    v_and_b32_dpp v23, v33, v11 row_newbcast:12 row_mask:0xf bank_mask:0xf
    s_waitcnt vmcnt(18)
    buffer_load_dwordx4 v[184:187], v43, s[36:39], s53 offen offset:512 nt
    buffer_load_dwordx4 v[188:191], v43, s[36:39], s53 offen offset:768 nt
    s_add_u32 s68, s53, 4096
    s_xor_b32 s69, s68, s53
    s_and_b32 s69, s69, 65536
    s_add_u32 s53, s68, s69
    v_mfma_f32_16x16x32_bf16 v[24:27], v[16:19], v[72:75], v[24:27]
    v_mfma_f32_16x16x32_bf16 v[24:27], v[20:23], v[76:79], v[24:27]
    v_and_b32_dpp v16, v33, v8 row_newbcast:1 row_mask:0xf bank_mask:0xf
    v_and_b32_dpp v17, v33, v9 row_newbcast:1 row_mask:0xf bank_mask:0xf
    v_and_b32_dpp v18, v33, v10 row_newbcast:1 row_mask:0xf bank_mask:0xf
    v_and_b32_dpp v19, v33, v11 row_newbcast:1 row_mask:0xf bank_mask:0xf
    v_and_b32_dpp v20, v33, v8 row_newbcast:5 row_mask:0xf bank_mask:0xf
    v_and_b32_dpp v21, v33, v9 row_newbcast:5 row_mask:0xf bank_mask:0xf
    v_and_b32_dpp v22, v33, v10 row_newbcast:5 row_mask:0xf bank_mask:0xf
    v_and_b32_dpp v23, v33, v11 row_newbcast:5 row_mask:0xf bank_mask:0xf
    s_nop 0
    v_mfma_f32_16x16x32_bf16 v[24:27], v[16:19], v[80:83], v[24:27]
    v_mfma_f32_16x16x32_bf16 v[24:27], v[20:23], v[84:87], v[24:27]
    v_and_b32_dpp v16, v33, v8 row_newbcast:9 row_mask:0xf bank_mask:0xf
    v_and_b32_dpp v17, v33, v9 row_newbcast:9 row_mask:0xf bank_mask:0xf
    v_and_b32_dpp v18, v33, v10 row_newbcast:9 row_mask:0xf bank_mask:0xf
    v_and_b32_dpp v19, v33, v11 row_newbcast:9 row_mask:0xf bank_mask:0xf
    v_and_b32_dpp v20, v33, v8 row_newbcast:13 row_mask:0xf bank_mask:0xf
    v_and_b32_dpp v21, v33, v9 row_newbcast:13 row_mask:0xf bank_mask:0xf
    v_and_b32_dpp v22, v33, v10 row_newbcast:13 row_mask:0xf bank_mask:0xf
    v_and_b32_dpp v23, v33, v11 row_newbcast:13 row_mask:0xf bank_mask:0xf
    s_nop 0
    v_mfma_f32_16x16x32_bf16 v[24:27], v[16:19], v[88:91], v[24:27]
    v_mfma_f32_16x16x32_bf16 v[24:27], v[20:23], v[92:95], v[24:27]
    v_and_b32_dpp v16, v33, v8 row_newbcast:2 row_mask:0xf bank_mask:0xf
    v_and_b32_dpp v17, v33, v9 row_newbcast:2 row_mask:0xf bank_mask:0xf
    v_and_b32_dpp v18, v33, v10 row_newbcast:2 row_mask:0xf bank_mask:0xf
    v_and_b32_dpp v19, v33, v11 row_newbcast:2 row_mask:0xf bank_mask:0xf
    v_and_b32_dpp v20, v33, v8 row_newbcast:6 row_mask:0xf bank_mask:0xf
    v_and_b32_dpp v21, v33, v9 row_newbcast:6 row_mask:0xf bank_mask:0xf
    v_and_b32_dpp v22, v33, v10 row_newbcast:6 row_mask:0xf bank_mask:0xf
    v_and_b32_dpp v23, v33, v11 row_newbcast:6 row_mask:0xf bank_mask:0xf
    s_nop 0
    v_mfma_f32_16x16x32_bf16 v[24:27], v[16:19], v[96:99], v[24:27]
    v_mfma_f32_16x16x32_bf16 v[24:27], v[20:23], v[100:103], v[24:27]
    v_and_b32_dpp v16, v33, v8 row_newbcast:10 row_mask:0xf bank_mask:0xf
    v_and_b32_dpp v17, v33, v9 row_newbcast:10 row_mask:0xf bank_mask:0xf
    v_and_b32_dpp v18, v33, v10 row_newbcast:10 row_mask:0xf bank_mask:0xf
    v_and_b32_dpp v19, v33, v11 row_newbcast:10 row_mask:0xf bank_mask:0xf
    v_and_b32_dpp v20, v33, v8 row_newbcast:14 row_mask:0xf bank_mask:0xf
    v_and_b32_dpp v21, v33, v9 row_newbcast:14 row_mask:0xf bank_mask:0xf
    v_and_b32_dpp v22, v33, v10 row_newbcast:14 row_mask:0xf bank_mask:0xf
    v_and_b32_dpp v23, v33, v11 row_newbcast:14 row_mask:0xf bank_mask:0xf
    s_nop 0
    v_mfma_f32_16x16x32_bf16 v[24:27], v[16:19], v[104:107], v[24:27]
    v_mfma_f32_16x16x32_bf16 v[24:27], v[20:23], v[108:111], v[24:27]
    v_and_b32_dpp v16, v33, v8 row_newbcast:3 row_mask:0xf bank_mask:0xf
    v_and_b32_dpp v17, v33, v9 row_newbcast:3 row_mask:0xf bank_mask:0xf
    v_and_b32_dpp v18, v33, v10 row_newbcast:3 row_mask:0xf bank_mask:0xf
    v_and_b32_dpp v19, v33, v11 row_newbcast:3 row_mask:0xf bank_mask:0xf
    v_and_b32_dpp v20, v33, v8 row_newbcast:7 row_mask:0xf bank_mask:0xf
    v_and_b32_dpp v21, v33, v9 row_newbcast:7 row_mask:0xf bank_mask:0xf
    v_and_b32_dpp v22, v33, v10 row_newbcast:7 row_mask:0xf bank_mask:0xf
    v_and_b32_dpp v23, v33, v11 row_newbcast:7 row_mask:0xf bank_mask:0xf
    s_waitcnt vmcnt(18)
    v_mfma_f32_16x16x32_bf16 v[24:27], v[16:19], v[112:115], v[24:27]
    v_mfma_f32_16x16x32_bf16 v[24:27], v[20:23], v[116:119], v[24:27]
    v_and_b32_dpp v16, v33, v8 row_newbcast:11 row_mask:0xf bank_mask:0xf
    v_and_b32_dpp v17, v33, v9 row_newbcast:11 row_mask:0xf bank_mask:0xf
    v_and_b32_dpp v18, v33, v10 row_newbcast:11 row_mask:0xf bank_mask:0xf
    v_and_b32_dpp v19, v33, v11 row_newbcast:11 row_mask:0xf bank_mask:0xf
    v_and_b32_dpp v20, v33, v8 row_newbcast:15 row_mask:0xf bank_mask:0xf
    v_and_b32_dpp v21, v33, v9 row_newbcast:15 row_mask:0xf bank_mask:0xf
    v_and_b32_dpp v22, v33, v10 row_newbcast:15 row_mask:0xf bank_mask:0xf
    v_and_b32_dpp v23, v33, v11 row_newbcast:15 row_mask:0xf bank_mask:0xf
    s_waitcnt vmcnt(16)
    v_mfma_f32_16x16x32_bf16 v[24:27], v[16:19], v[120:123], v[24:27]
    v_mfma_f32_16x16x32_bf16 v[24:27], v[20:23], v[124:127], v[24:27]
    s_waitcnt lgkmcnt(0)
    v_fma_f32 v31, v30, s55, -v35
    v_exp_f32 v31, v31
    s_nop 0
    v_cvt_pk_bf16_f32 v33, v31, v31
    v_add_f32 v36, v36, v31
    s_nop 0
    v_and_b32_dpp v16, v33, v8 row_newbcast:0 row_mask:0xf bank_mask:0xf
    v_and_b32_dpp v17, v33, v9 row_newbcast:0 row_mask:0xf bank_mask:0xf
    v_and_b32_dpp v18, v33, v10 row_newbcast:0 row_mask:0xf bank_mask:0xf
    v_and_b32_dpp v19, v33, v11 row_newbcast:0 row_mask:0xf bank_mask:0xf
    v_and_b32_dpp v20, v33, v8 row_newbcast:4 row_mask:0xf bank_mask:0xf
    v_and_b32_dpp v21, v33, v9 row_newbcast:4 row_mask:0xf bank_mask:0xf
    v_and_b32_dpp v22, v33, v10 row_newbcast:4 row_mask:0xf bank_mask:0xf
    v_and_b32_dpp v23, v33, v11 row_newbcast:4 row_mask:0xf bank_mask:0xf
    v_add_f32_dpp v36, v36, v36 row_ror:8 row_mask:0xf bank_mask:0xf
    s_nop 1
    v_add_f32_dpp v36, v36, v36 row_ror:4 row_mask:0xf bank_mask:0xf
    s_nop 1
    v_add_f32_dpp v36, v36, v36 row_ror:2 row_mask:0xf bank_mask:0xf
    s_nop 1
    v_add_f32_dpp v36, v36, v36 row_ror:1 row_mask:0xf bank_mask:0xf
    s_nop 1
    v_mov_b32 v31, v36
    s_nop 1
    v_permlane16_swap_b32 v36, v31
    v_add_f32 v36, v36, v31
    v_mov_b32 v31, v36
    s_nop 1
    v_permlane32_swap_b32 v36, v31
    v_add_f32 v36, v36, v31
    v_rcp_f32 v36, v36
    ds_read_b32 v32, v13 offset:8
    s_waitcnt lgkmcnt(0)
    v_readfirstlane_b32 s60, v32
    s_waitcnt vmcnt(14)
    v_mfma_f32_16x16x32_bf16 v[24:27], v[16:19], v[128:131], v[24:27]
    v_mfma_f32_16x16x32_bf16 v[24:27], v[20:23], v[132:135], v[24:27]
    v_and_b32_dpp v16, v33, v8 row_newbcast:8 row_mask:0xf bank_mask:0xf
    v_and_b32_dpp v17, v33, v9 row_newbcast:8 row_mask:0xf bank_mask:0xf
    v_and_b32_dpp v18, v33, v10 row_newbcast:8 row_mask:0xf bank_mask:0xf
    v_and_b32_dpp v19, v33, v11 row_newbcast:8 row_mask:0xf bank_mask:0xf
    v_and_b32_dpp v20, v33, v8 row_newbcast:12 row_mask:0xf bank_mask:0xf
    v_and_b32_dpp v21, v33, v9 row_newbcast:12 row_mask:0xf bank_mask:0xf
    v_and_b32_dpp v22, v33, v10 row_newbcast:12 row_mask:0xf bank_mask:0xf
    v_and_b32_dpp v23, v33, v11 row_newbcast:12 row_mask:0xf bank_mask:0xf
    s_waitcnt vmcnt(12)
    v_mfma_f32_16x16x32_bf16 v[24:27], v[16:19], v[136:139], v[24:27]
    v_mfma_f32_16x16x32_bf16 v[24:27], v[20:23], v[140:143], v[24:27]
    v_and_b32_dpp v16, v33, v8 row_newbcast:1 row_mask:0xf bank_mask:0xf
    v_and_b32_dpp v17, v33, v9 row_newbcast:1 row_mask:0xf bank_mask:0xf
    v_and_b32_dpp v18, v33, v10 row_newbcast:1 row_mask:0xf bank_mask:0xf
    v_and_b32_dpp v19, v33, v11 row_newbcast:1 row_mask:0xf bank_mask:0xf
    v_and_b32_dpp v20, v33, v8 row_newbcast:5 row_mask:0xf bank_mask:0xf
    v_and_b32_dpp v21, v33, v9 row_newbcast:5 row_mask:0xf bank_mask:0xf
    v_and_b32_dpp v22, v33, v10 row_newbcast:5 row_mask:0xf bank_mask:0xf
    v_and_b32_dpp v23, v33, v11 row_newbcast:5 row_mask:0xf bank_mask:0xf
    s_waitcnt vmcnt(10)
    v_mfma_f32_16x16x32_bf16 v[24:27], v[16:19], v[144:147], v[24:27]
    v_mfma_f32_16x16x32_bf16 v[24:27], v[20:23], v[148:151], v[24:27]
    v_and_b32_dpp v16, v33, v8 row_newbcast:9 row_mask:0xf bank_mask:0xf
    v_and_b32_dpp v17, v33, v9 row_newbcast:9 row_mask:0xf bank_mask:0xf
    v_and_b32_dpp v18, v33, v10 row_newbcast:9 row_mask:0xf bank_mask:0xf
    v_and_b32_dpp v19, v33, v11 row_newbcast:9 row_mask:0xf bank_mask:0xf
    v_and_b32_dpp v20, v33, v8 row_newbcast:13 row_mask:0xf bank_mask:0xf
    v_and_b32_dpp v21, v33, v9 row_newbcast:13 row_mask:0xf bank_mask:0xf
    v_and_b32_dpp v22, v33, v10 row_newbcast:13 row_mask:0xf bank_mask:0xf
    v_and_b32_dpp v23, v33, v11 row_newbcast:13 row_mask:0xf bank_mask:0xf
    s_waitcnt vmcnt(8)
    v_mfma_f32_16x16x32_bf16 v[24:27], v[16:19], v[152:155], v[24:27]
    v_mfma_f32_16x16x32_bf16 v[24:27], v[20:23], v[156:159], v[24:27]
    v_and_b32_dpp v16, v33, v8 row_newbcast:2 row_mask:0xf bank_mask:0xf
    v_and_b32_dpp v17, v33, v9 row_newbcast:2 row_mask:0xf bank_mask:0xf
    v_and_b32_dpp v18, v33, v10 row_newbcast:2 row_mask:0xf bank_mask:0xf
    v_and_b32_dpp v19, v33, v11 row_newbcast:2 row_mask:0xf bank_mask:0xf
    v_and_b32_dpp v20, v33, v8 row_newbcast:6 row_mask:0xf bank_mask:0xf
    v_and_b32_dpp v21, v33, v9 row_newbcast:6 row_mask:0xf bank_mask:0xf
    v_and_b32_dpp v22, v33, v10 row_newbcast:6 row_mask:0xf bank_mask:0xf
    v_and_b32_dpp v23, v33, v11 row_newbcast:6 row_mask:0xf bank_mask:0xf
    s_waitcnt vmcnt(6)
    v_mfma_f32_16x16x32_bf16 v[24:27], v[16:19], v[160:163], v[24:27]
    v_mfma_f32_16x16x32_bf16 v[24:27], v[20:23], v[164:167], v[24:27]
    v_and_b32_dpp v16, v33, v8 row_newbcast:10 row_mask:0xf bank_mask:0xf
    v_and_b32_dpp v17, v33, v9 row_newbcast:10 row_mask:0xf bank_mask:0xf
    v_and_b32_dpp v18, v33, v10 row_newbcast:10 row_mask:0xf bank_mask:0xf
    v_and_b32_dpp v19, v33, v11 row_newbcast:10 row_mask:0xf bank_mask:0xf
    v_and_b32_dpp v20, v33, v8 row_newbcast:14 row_mask:0xf bank_mask:0xf
    v_and_b32_dpp v21, v33, v9 row_newbcast:14 row_mask:0xf bank_mask:0xf
    v_and_b32_dpp v22, v33, v10 row_newbcast:14 row_mask:0xf bank_mask:0xf
    v_and_b32_dpp v23, v33, v11 row_newbcast:14 row_mask:0xf bank_mask:0xf
    s_waitcnt vmcnt(4)
    v_mfma_f32_16x16x32_bf16 v[24:27], v[16:19], v[168:171], v[24:27]
    v_mfma_f32_16x16x32_bf16 v[24:27], v[20:23], v[172:175], v[24:27]
    v_and_b32_dpp v16, v33, v8 row_newbcast:3 row_mask:0xf bank_mask:0xf
    v_and_b32_dpp v17, v33, v9 row_newbcast:3 row_mask:0xf bank_mask:0xf
    v_and_b32_dpp v18, v33, v10 row_newbcast:3 row_mask:0xf bank_mask:0xf
    v_and_b32_dpp v19, v33, v11 row_newbcast:3 row_mask:0xf bank_mask:0xf
    v_and_b32_dpp v20, v33, v8 row_newbcast:7 row_mask:0xf bank_mask:0xf
    v_and_b32_dpp v21, v33, v9 row_newbcast:7 row_mask:0xf bank_mask:0xf
    v_and_b32_dpp v22, v33, v10 row_newbcast:7 row_mask:0xf bank_mask:0xf
    v_and_b32_dpp v23, v33, v11 row_newbcast:7 row_mask:0xf bank_mask:0xf
    s_waitcnt vmcnt(2)
    v_mfma_f32_16x16x32_bf16 v[24:27], v[16:19], v[176:179], v[24:27]
    v_mfma_f32_16x16x32_bf16 v[24:27], v[20:23], v[180:183], v[24:27]
    v_and_b32_dpp v16, v33, v8 row_newbcast:11 row_mask:0xf bank_mask:0xf
    v_and_b32_dpp v17, v33, v9 row_newbcast:11 row_mask:0xf bank_mask:0xf
    v_and_b32_dpp v18, v33, v10 row_newbcast:11 row_mask:0xf bank_mask:0xf
    v_and_b32_dpp v19, v33, v11 row_newbcast:11 row_mask:0xf bank_mask:0xf
    v_and_b32_dpp v20, v33, v8 row_newbcast:15 row_mask:0xf bank_mask:0xf
    v_and_b32_dpp v21, v33, v9 row_newbcast:15 row_mask:0xf bank_mask:0xf
    v_and_b32_dpp v22, v33, v10 row_newbcast:15 row_mask:0xf bank_mask:0xf
    v_and_b32_dpp v23, v33, v11 row_newbcast:15 row_mask:0xf bank_mask:0xf
    s_waitcnt vmcnt(0)
    v_mfma_f32_16x16x32_bf16 v[24:27], v[16:19], v[184:187], v[24:27]
    v_mfma_f32_16x16x32_bf16 v[24:27], v[20:23], v[188:191], v[24:27]
    s_mov_b32 exec_hi, 0
    s_cmp_eq_u32 s60, 1
    s_nop 5
    v_mul_f32 v4, v24, v36
    v_mul_f32 v5, v25, v36
    v_mul_f32 v6, v26, v36
    v_mul_f32 v7, v27, v36
    v_cvt_pk_bf16_f32 v2, v4, v5
    v_cvt_pk_bf16_f32 v3, v6, v7
    v_lshl_or_b32 v4, v2, 16, v60
    v_and_or_b32 v5, v2, s63, v61
    v_lshl_or_b32 v6, v3, 16, v62
    v_and_or_b32 v7, v3, s63, v63
    s_cbranch_scc1 L_oloc
    buffer_store_dwordx4 v[4:7], v37, s[48:51], s57 offen sc1
    s_branch L_odone
L_oloc:
    buffer_store_dwordx4 v[4:7], v37, s[48:51], s57 offen
L_odone:
    s_barrier
    s_endpgm
L_midB:
    s_barrier
    s_lshr_b32 s75, s75, 8
    s_and_b32 s74, s75, 0xff
    s_branch L_midBback
L_midC:
    s_barrier
    s_branch L_midCback
L_loopVf:
    ds_read_b32 v32, v13
    s_waitcnt vmcnt(22)
    buffer_load_dwordx4 v[176:179], v43, s[36:39], s53 offen offset:0 nt
    buffer_load_dwordx4 v[180:183], v43, s[36:39], s53 offen offset:256 nt
    v_mfma_f32_16x16x32_bf16 v[24:27], v[16:19], v[64:67], v[24:27]
    v_mfma_f32_16x16x32_bf16 v[24:27], v[20:23], v[68:71], v[24:27]
    v_and_b32_dpp v16, v33, v8 row_newbcast:8 row_mask:0xf bank_mask:0xf
    v_and_b32_dpp v17, v33, v9 row_newbcast:8 row_mask:0xf bank_mask:0xf
    v_and_b32_dpp v18, v33, v10 row_newbcast:8 row_mask:0xf bank_mask:0xf
    v_and_b32_dpp v19, v33, v11 row_newbcast:8 row_mask:0xf bank_mask:0xf
    v_and_b32_dpp v20, v33, v8 row_newbcast:12 row_mask:0xf bank_mask:0xf
    v_and_b32_dpp v21, v33, v9 row_newbcast:12 row_mask:0xf bank_mask:0xf
    v_and_b32_dpp v22, v33, v10 row_newbcast:12 row_mask:0xf bank_mask:0xf
    v_and_b32_dpp v23, v33, v11 row_newbcast:12 row_mask:0xf bank_mask:0xf
    s_waitcnt vmcnt(22)
    buffer_load_dwordx4 v[184:187], v43, s[36:39], s53 offen offset:512 nt
    buffer_load_dwordx4 v[188:191], v43, s[36:39], s53 offen offset:768 nt
    s_add_u32 s68, s53, 4096
    s_xor_b32 s69, s68, s53
    s_and_b32 s69, s69, 65536
    s_add_u32 s53, s68, s69
    v_mfma_f32_16x16x32_bf16 v[24:27], v[16:19], v[72:75], v[24:27]
    v_mfma_f32_16x16x32_bf16 v[24:27], v[20:23], v[76:79], v[24:27]
    v_and_b32_dpp v16, v33, v8 row_newbcast:1 row_mask:0xf bank_mask:0xf
    v_and_b32_dpp v17, v33, v9 row_newbcast:1 row_mask:0xf bank_mask:0xf
    v_and_b32_dpp v18, v33, v10 row_newbcast:1 row_mask:0xf bank_mask:0xf
    v_and_b32_dpp v19, v33, v11 row_newbcast:1 row_mask:0xf bank_mask:0xf
    v_and_b32_dpp v20, v33, v8 row_newbcast:5 row_mask:0xf bank_mask:0xf
    v_and_b32_dpp v21, v33, v9 row_newbcast:5 row_mask:0xf bank_mask:0xf
    v_and_b32_dpp v22, v33, v10 row_newbcast:5 row_mask:0xf bank_mask:0xf
    v_and_b32_dpp v23, v33, v11 row_newbcast:5 row_mask:0xf bank_mask:0xf
    s_waitcnt vmcnt(22)
    buffer_load_dwordx4 v[64:67], v42, s[36:39], s53 offen offset:0 nt
    buffer_load_dwordx4 v[68:71], v42, s[36:39], s53 offen offset:256 nt
    v_mfma_f32_16x16x32_bf16 v[24:27], v[16:19], v[80:83], v[24:27]
    v_mfma_f32_16x16x32_bf16 v[24:27], v[20:23], v[84:87], v[24:27]
    v_and_b32_dpp v16, v33, v8 row_newbcast:9 row_mask:0xf bank_mask:0xf
    v_and_b32_dpp v17, v33, v9 row_newbcast:9 row_mask:0xf bank_mask:0xf
    v_and_b32_dpp v18, v33, v10 row_newbcast:9 row_mask:0xf bank_mask:0xf
    v_and_b32_dpp v19, v33, v11 row_newbcast:9 row_mask:0xf bank_mask:0xf
    v_and_b32_dpp v20, v33, v8 row_newbcast:13 row_mask:0xf bank_mask:0xf
    v_and_b32_dpp v21, v33, v9 row_newbcast:13 row_mask:0xf bank_mask:0xf
    v_and_b32_dpp v22, v33, v10 row_newbcast:13 row_mask:0xf bank_mask:0xf
    v_and_b32_dpp v23, v33, v11 row_newbcast:13 row_mask:0xf bank_mask:0xf
    s_waitcnt vmcnt(22)
    buffer_load_dwordx4 v[72:75], v42, s[36:39], s53 offen offset:512 nt
    buffer_load_dwordx4 v[76:79], v42, s[36:39], s53 offen offset:768 nt
    v_mfma_f32_16x16x32_bf16 v[24:27], v[16:19], v[88:91], v[24:27]
    v_mfma_f32_16x16x32_bf16 v[24:27], v[20:23], v[92:95], v[24:27]
    v_and_b32_dpp v16, v33, v8 row_newbcast:2 row_mask:0xf bank_mask:0xf
    v_and_b32_dpp v17, v33, v9 row_newbcast:2 row_mask:0xf bank_mask:0xf
    v_and_b32_dpp v18, v33, v10 row_newbcast:2 row_mask:0xf bank_mask:0xf
    v_and_b32_dpp v19, v33, v11 row_newbcast:2 row_mask:0xf bank_mask:0xf
    v_and_b32_dpp v20, v33, v8 row_newbcast:6 row_mask:0xf bank_mask:0xf
    v_and_b32_dpp v21, v33, v9 row_newbcast:6 row_mask:0xf bank_mask:0xf
    v_and_b32_dpp v22, v33, v10 row_newbcast:6 row_mask:0xf bank_mask:0xf
    v_and_b32_dpp v23, v33, v11 row_newbcast:6 row_mask:0xf bank_mask:0xf
    s_waitcnt vmcnt(22)
    buffer_load_dwordx4 v[80:83], v43, s[36:39], s53 offen offset:0 nt
    buffer_load_dwordx4 v[84:87], v43, s[36:39], s53 offen offset:256 nt
    v_mfma_f32_16x16x32_bf16 v[24:27], v[16:19], v[96:99], v[24:27]
    v_mfma_f32_16x16x32_bf16 v[24:27], v[20:23], v[100:103], v[24:27]
    v_and_b32_dpp v16, v33, v8 row_newbcast:10 row_mask:0xf bank_mask:0xf
    v_and_b32_dpp v17, v33, v9 row_newbcast:10 row_mask:0xf bank_mask:0xf
    v_and_b32_dpp v18, v33, v10 row_newbcast:10 row_mask:0xf bank_mask:0xf
    v_and_b32_dpp v19, v33, v11 row_newbcast:10 row_mask:0xf bank_mask:0xf
    v_and_b32_dpp v20, v33, v8 row_newbcast:14 row_mask:0xf bank_mask:0xf
    v_and_b32_dpp v21, v33, v9 row_newbcast:14 row_mask:0xf bank_mask:0xf
    v_and_b32_dpp v22, v33, v10 row_newbcast:14 row_mask:0xf bank_mask:0xf
    v_and_b32_dpp v23, v33, v11 row_newbcast:14 row_mask:0xf bank_mask:0xf
    s_waitcnt vmcnt(22)
    buffer_load_dwordx4 v[88:91], v43, s[36:39], s53 offen offset:512 nt
    buffer_load_dwordx4 v[92:95], v43, s[36:39], s53 offen offset:768 nt
    s_add_u32 s68, s53, 4096
    s_xor_b32 s69, s68, s53
    s_and_b32 s69, s69, 65536
    s_add_u32 s53, s68, s69
    v_mfma_f32_16x16x32_bf16 v[24:27], v[16:19], v[104:107], v[24:27]
    v_mfma_f32_16x16x32_bf16 v[24:27], v[20:23], v[108:111], v[24:27]
    v_and_b32_dpp v16, v33, v8 row_newbcast:3 row_mask:0xf bank_mask:0xf
    v_and_b32_dpp v17, v33, v9 row_newbcast:3 row_mask:0xf bank_mask:0xf
    v_and_b32_dpp v18, v33, v10 row_newbcast:3 row_mask:0xf bank_mask:0xf
    v_and_b32_dpp v19, v33, v11 row_newbcast:3 row_mask:0xf bank_mask:0xf
    v_and_b32_dpp v20, v33, v8 row_newbcast:7 row_mask:0xf bank_mask:0xf
    v_and_b32_dpp v21, v33, v9 row_newbcast:7 row_mask:0xf bank_mask:0xf
    v_and_b32_dpp v22, v33, v10 row_newbcast:7 row_mask:0xf bank_mask:0xf
    v_and_b32_dpp v23, v33, v11 row_newbcast:7 row_mask:0xf bank_mask:0xf
    s_waitcnt vmcnt(22)
    buffer_load_dwordx4 v[96:99], v42, s[36:39], s53 offen offset:0 nt
    buffer_load_dwordx4 v[100:103], v42, s[36:39], s53 offen offset:256 nt
    v_mfma_f32_16x16x32_bf16 v[24:27], v[16:19], v[112:115], v[24:27]
    v_mfma_f32_16x16x32_bf16 v[24:27], v[20:23], v[116:119], v[24:27]
    v_and_b32_dpp v16, v33, v8 row_newbcast:11 row_mask:0xf bank_mask:0xf
    v_and_b32_dpp v17, v33, v9 row_newbcast:11 row_mask:0xf bank_mask:0xf
    v_and_b32_dpp v18, v33, v10 row_newbcast:11 row_mask:0xf bank_mask:0xf
    v_and_b32_dpp v19, v33, v11 row_newbcast:11 row_mask:0xf bank_mask:0xf
    v_and_b32_dpp v20, v33, v8 row_newbcast:15 row_mask:0xf bank_mask:0xf
    v_and_b32_dpp v21, v33, v9 row_newbcast:15 row_mask:0xf bank_mask:0xf
    v_and_b32_dpp v22, v33, v10 row_newbcast:15 row_mask:0xf bank_mask:0xf
    v_and_b32_dpp v23, v33, v11 row_newbcast:15 row_mask:0xf bank_mask:0xf
    s_waitcnt vmcnt(22)
    buffer_load_dwordx4 v[104:107], v42, s[36:39], s53 offen offset:512 nt
    buffer_load_dwordx4 v[108:111], v42, s[36:39], s53 offen offset:768 nt
    v_mfma_f32_16x16x32_bf16 v[24:27], v[16:19], v[120:123], v[24:27]
    v_mfma_f32_16x16x32_bf16 v[24:27], v[20:23], v[124:127], v[24:27]
    s_waitcnt lgkmcnt(0)
    v_fma_f32 v31, v30, s55, -v35
    v_exp_f32 v31, v31
    v_add_u32 v38, 512, v38
    ds_read_b32 v30, v38 offset:0
    v_cvt_pk_bf16_f32 v33, v31, v31
    v_add_f32 v36, v36, v31
    s_nop 0
    v_and_b32_dpp v16, v33, v8 row_newbcast:0 row_mask:0xf bank_mask:0xf
    v_and_b32_dpp v17, v33, v9 row_newbcast:0 row_mask:0xf bank_mask:0xf
    v_and_b32_dpp v18, v33, v10 row_newbcast:0 row_mask:0xf bank_mask:0xf
    v_and_b32_dpp v19, v33, v11 row_newbcast:0 row_mask:0xf bank_mask:0xf
    v_and_b32_dpp v20, v33, v8 row_newbcast:4 row_mask:0xf bank_mask:0xf
    v_and_b32_dpp v21, v33, v9 row_newbcast:4 row_mask:0xf bank_mask:0xf
    v_and_b32_dpp v22, v33, v10 row_newbcast:4 row_mask:0xf bank_mask:0xf
    v_and_b32_dpp v23, v33, v11 row_newbcast:4 row_mask:0xf bank_mask:0xf
    s_waitcnt vmcnt(22)
    buffer_load_dwordx4 v[112:115], v43, s[36:39], s53 offen offset:0 nt
    buffer_load_dwordx4 v[116:119], v43, s[36:39], s53 offen offset:256 nt
    v_mfma_f32_16x16x32_bf16 v[24:27], v[16:19], v[128:131], v[24:27]
    v_mfma_f32_16x16x32_bf16 v[24:27], v[20:23], v[132:135], v[24:27]
    v_and_b32_dpp v16, v33, v8 row_newbcast:8 row_mask:0xf bank_mask:0xf
    v_and_b32_dpp v17, v33, v9 row_newbcast:8 row_mask:0xf bank_mask:0xf
    v_and_b32_dpp v18, v33, v10 row_newbcast:8 row_mask:0xf bank_mask:0xf
    v_and_b32_dpp v19, v33, v11 row_newbcast:8 row_mask:0xf bank_mask:0xf
    v_and_b32_dpp v20, v33, v8 row_newbcast:12 row_mask:0xf bank_mask:0xf
    v_and_b32_dpp v21, v33, v9 row_newbcast:12 row_mask:0xf bank_mask:0xf
    v_and_b32_dpp v22, v33, v10 row_newbcast:12 row_mask:0xf bank_mask:0xf
    v_and_b32_dpp v23, v33, v11 row_newbcast:12 row_mask:0xf bank_mask:0xf
    s_waitcnt vmcnt(22)
    buffer_load_dwordx4 v[120:123], v43, s[36:39], s53 offen offset:512 nt
    buffer_load_dwordx4 v[124:127], v43, s[36:39], s53 offen offset:768 nt
    s_add_u32 s68, s53, 4096
    s_xor_b32 s69, s68, s53
    s_and_b32 s69, s69, 65536
    s_add_u32 s53, s68, s69
    v_mfma_f32_16x16x32_bf16 v[24:27], v[16:19], v[136:139], v[24:27]
    v_mfma_f32_16x16x32_bf16 v[24:27], v[20:23], v[140:143], v[24:27]
    v_and_b32_dpp v16, v33, v8 row_newbcast:1 row_mask:0xf bank_mask:0xf
    v_and_b32_dpp v17, v33, v9 row_newbcast:1 row_mask:0xf bank_mask:0xf
    v_and_b32_dpp v18, v33, v10 row_newbcast:1 row_mask:0xf bank_mask:0xf
    v_and_b32_dpp v19, v33, v11 row_newbcast:1 row_mask:0xf bank_mask:0xf
    v_and_b32_dpp v20, v33, v8 row_newbcast:5 row_mask:0xf bank_mask:0xf
    v_and_b32_dpp v21, v33, v9 row_newbcast:5 row_mask:0xf bank_mask:0xf
    v_and_b32_dpp v22, v33, v10 row_newbcast:5 row_mask:0xf bank_mask:0xf
    v_and_b32_dpp v23, v33, v11 row_newbcast:5 row_mask:0xf bank_mask:0xf
    s_waitcnt vmcnt(22)
    buffer_load_dwordx4 v[128:131], v42, s[36:39], s53 offen offset:0 nt
    buffer_load_dwordx4 v[132:135], v42, s[36:39], s53 offen offset:256 nt
    v_mfma_f32_16x16x32_bf16 v[24:27], v[16:19], v[144:147], v[24:27]
    v_mfma_f32_16x16x32_bf16 v[24:27], v[20:23], v[148:151], v[24:27]
    v_and_b32_dpp v16, v33, v8 row_newbcast:9 row_mask:0xf bank_mask:0xf
    v_and_b32_dpp v17, v33, v9 row_newbcast:9 row_mask:0xf bank_mask:0xf
    v_and_b32_dpp v18, v33, v10 row_newbcast:9 row_mask:0xf bank_mask:0xf
    v_and_b32_dpp v19, v33, v11 row_newbcast:9 row_mask:0xf bank_mask:0xf
    v_and_b32_dpp v20, v33, v8 row_newbcast:13 row_mask:0xf bank_mask:0xf
    v_and_b32_dpp v21, v33, v9 row_newbcast:13 row_mask:0xf bank_mask:0xf
    v_and_b32_dpp v22, v33, v10 row_newbcast:13 row_mask:0xf bank_mask:0xf
    v_and_b32_dpp v23, v33, v11 row_newbcast:13 row_mask:0xf bank_mask:0xf
    s_waitcnt vmcnt(22)
    buffer_load_dwordx4 v[136:139], v42, s[36:39], s53 offen offset:512 nt
    buffer_load_dwordx4 v[140:143], v42, s[36:39], s53 offen offset:768 nt
    v_mfma_f32_16x16x32_bf16 v[24:27], v[16:19], v[152:155], v[24:27]
    v_mfma_f32_16x16x32_bf16 v[24:27], v[20:23], v[156:159], v[24:27]
    v_and_b32_dpp v16, v33, v8 row_newbcast:2 row_mask:0xf bank_mask:0xf
    v_and_b32_dpp v17, v33, v9 row_newbcast:2 row_mask:0xf bank_mask:0xf
    v_and_b32_dpp v18, v33, v10 row_newbcast:2 row_mask:0xf bank_mask:0xf
    v_and_b32_dpp v19, v33, v11 row_newbcast:2 row_mask:0xf bank_mask:0xf
    v_and_b32_dpp v20, v33, v8 row_newbcast:6 row_mask:0xf bank_mask:0xf
    v_and_b32_dpp v21, v33, v9 row_newbcast:6 row_mask:0xf bank_mask:0xf
    v_and_b32_dpp v22, v33, v10 row_newbcast:6 row_mask:0xf bank_mask:0xf
    v_and_b32_dpp v23, v33, v11 row_newbcast:6 row_mask:0xf bank_mask:0xf
    s_waitcnt vmcnt(22)
    buffer_load_dwordx4 v[144:147], v43, s[36:39], s53 offen offset:0 nt
    buffer_load_dwordx4 v[148:151], v43, s[36:39], s53 offen offset:256 nt
    v_mfma_f32_16x16x32_bf16 v[24:27], v[16:19], v[160:163], v[24:27]
    v_mfma_f32_16x16x32_bf16 v[24:27], v[20:23], v[164:167], v[24:27]
    v_and_b32_dpp v16, v33, v8 row_newbcast:10 row_mask:0xf bank_mask:0xf
    v_and_b32_dpp v17, v33, v9 row_newbcast:10 row_mask:0xf bank_mask:0xf
    v_and_b32_dpp v18, v33, v10 row_newbcast:10 row_mask:0xf bank_mask:0xf
    v_and_b32_dpp v19, v33, v11 row_newbcast:10 row_mask:0xf bank_mask:0xf
    v_and_b32_dpp v20, v33, v8 row_newbcast:14 row_mask:0xf bank_mask:0xf
    v_and_b32_dpp v21, v33, v9 row_newbcast:14 row_mask:0xf bank_mask:0xf
    v_and_b32_dpp v22, v33, v10 row_newbcast:14 row_mask:0xf bank_mask:0xf
    v_and_b32_dpp v23, v33, v11 row_newbcast:14 row_mask:0xf bank_mask:0xf
    s_waitcnt vmcnt(22)
    buffer_load_dwordx4 v[152:155], v43, s[36:39], s53 offen offset:512 nt
    buffer_load_dwordx4 v[156:159], v43, s[36:39], s53 offen offset:768 nt
    s_add_u32 s68, s53, 4096
    s_xor_b32 s69, s68, s53
    s_and_b32 s69, s69, 65536
    s_add_u32 s53, s68, s69
    v_mfma_f32_16x16x32_bf16 v[24:27], v[16:19], v[168:171], v[24:27]
    v_mfma_f32_16x16x32_bf16 v[24:27], v[20:23], v[172:175], v[24:27]
    v_and_b32_dpp v16, v33, v8 row_newbcast:3 row_mask:0xf bank_mask:0xf
    v_and_b32_dpp v17, v33, v9 row_newbcast:3 row_mask:0xf bank_mask:0xf
    v_and_b32_dpp v18, v33, v10 row_newbcast:3 row_mask:0xf bank_mask:0xf
    v_and_b32_dpp v19, v33, v11 row_newbcast:3 row_mask:0xf bank_mask:0xf
    v_and_b32_dpp v20, v33, v8 row_newbcast:7 row_mask:0xf bank_mask:0xf
    v_and_b32_dpp v21, v33, v9 row_newbcast:7 row_mask:0xf bank_mask:0xf
    v_and_b32_dpp v22, v33, v10 row_newbcast:7 row_mask:0xf bank_mask:0xf
    v_and_b32_dpp v23, v33, v11 row_newbcast:7 row_mask:0xf bank_mask:0xf
    s_waitcnt vmcnt(22)
    buffer_load_dwordx4 v[160:163], v42, s[36:39], s53 offen offset:0 nt
    buffer_load_dwordx4 v[164:167], v42, s[36:39], s53 offen offset:256 nt
    v_mfma_f32_16x16x32_bf16 v[24:27], v[16:19], v[176:179], v[24:27]
    v_mfma_f32_16x16x32_bf16 v[24:27], v[20:23], v[180:183], v[24:27]
    v_and_b32_dpp v16, v33, v8 row_newbcast:11 row_mask:0xf bank_mask:0xf
    v_and_b32_dpp v17, v33, v9 row_newbcast:11 row_mask:0xf bank_mask:0xf
    v_and_b32_dpp v18, v33, v10 row_newbcast:11 row_mask:0xf bank_mask:0xf
    v_and_b32_dpp v19, v33, v11 row_newbcast:11 row_mask:0xf bank_mask:0xf
    v_and_b32_dpp v20, v33, v8 row_newbcast:15 row_mask:0xf bank_mask:0xf
    v_and_b32_dpp v21, v33, v9 row_newbcast:15 row_mask:0xf bank_mask:0xf
    v_and_b32_dpp v22, v33, v10 row_newbcast:15 row_mask:0xf bank_mask:0xf
    v_and_b32_dpp v23, v33, v11 row_newbcast:15 row_mask:0xf bank_mask:0xf
    s_waitcnt vmcnt(22)
    buffer_load_dwordx4 v[168:171], v42, s[36:39], s53 offen offset:512 nt
    buffer_load_dwordx4 v[172:175], v42, s[36:39], s53 offen offset:768 nt
    v_mfma_f32_16x16x32_bf16 v[24:27], v[16:19], v[184:187], v[24:27]
    v_mfma_f32_16x16x32_bf16 v[24:27], v[20:23], v[188:191], v[24:27]
    s_waitcnt lgkmcnt(0)
    v_fma_f32 v31, v30, s55, -v35
    v_exp_f32 v31, v31
    ds_read_b32 v30, v38 offset:256
    v_cvt_pk_bf16_f32 v33, v31, v31
    v_add_f32 v36, v36, v31
    s_nop 0
    v_and_b32_dpp v16, v33, v8 row_newbcast:0 row_mask:0xf bank_mask:0xf
    v_and_b32_dpp v17, v33, v9 row_newbcast:0 row_mask:0xf bank_mask:0xf
    v_and_b32_dpp v18, v33, v10 row_newbcast:0 row_mask:0xf bank_mask:0xf
    v_and_b32_dpp v19, v33, v11 row_newbcast:0 row_mask:0xf bank_mask:0xf
    v_and_b32_dpp v20, v33, v8 row_newbcast:4 row_mask:0xf bank_mask:0xf
    v_and_b32_dpp v21, v33, v9 row_newbcast:4 row_mask:0xf bank_mask:0xf
    v_and_b32_dpp v22, v33, v10 row_newbcast:4 row_mask:0xf bank_mask:0xf
    v_and_b32_dpp v23, v33, v11 row_newbcast:4 row_mask:0xf bank_mask:0xf
    s_branch L_Vdisp
L_loopVs:
    ds_read_b32 v32, v13
    s_waitcnt vmcnt(16)
    buffer_load_dwordx4 v[176:179], v43, s[36:39], s53 offen offset:0 nt
    buffer_load_dwordx4 v[180:183], v43, s[36:39], s53 offen offset:256 nt
    v_mfma_f32_16x16x32_bf16 v[24:27], v[16:19], v[64:67], v[24:27]
    v_mfma_f32_16x16x32_bf16 v[24:27], v[20:23], v[68:71], v[24:27]
    v_and_b32_dpp v16, v33, v8 row_newbcast:8 row_mask:0xf bank_mask:0xf
    v_and_b32_dpp v17, v33, v9 row_newbcast:8 row_mask:0xf bank_mask:0xf
    v_and_b32_dpp v18, v33, v10 row_newbcast:8 row_mask:0xf bank_mask:0xf
    v_and_b32_dpp v19, v33, v11 row_newbcast:8 row_mask:0xf bank_mask:0xf
    v_and_b32_dpp v20, v33, v8 row_newbcast:12 row_mask:0xf bank_mask:0xf
    v_and_b32_dpp v21, v33, v9 row_newbcast:12 row_mask:0xf bank_mask:0xf
    v_and_b32_dpp v22, v33, v10 row_newbcast:12 row_mask:0xf bank_mask:0xf
    v_and_b32_dpp v23, v33, v11 row_newbcast:12 row_mask:0xf bank_mask:0xf
    s_waitcnt vmcnt(16)
    buffer_load_dwordx4 v[184:187], v43, s[36:39], s53 offen offset:512 nt
    buffer_load_dwordx4 v[188:191], v43, s[36:39], s53 offen offset:768 nt
    s_add_u32 s68, s53, 4096
    s_xor_b32 s69, s68, s53
    s_and_b32 s69, s69, 65536
    s_add_u32 s53, s68, s69
    v_mfma_f32_16x16x32_bf16 v[24:27], v[16:19], v[72:75], v[24:27]
    v_mfma_f32_16x16x32_bf16 v[24:27], v[20:23], v[76:79], v[24:27]
    v_and_b32_dpp v16, v33, v8 row_newbcast:1 row_mask:0xf bank_mask:0xf
    v_and_b32_dpp v17, v33, v9 row_newbcast:1 row_mask:0xf bank_mask:0xf
    v_and_b32_dpp v18, v33, v10 row_newbcast:1 row_mask:0xf bank_mask:0xf
    v_and_b32_dpp v19, v33, v11 row_newbcast:1 row_mask:0xf bank_mask:0xf
    v_and_b32_dpp v20, v33, v8 row_newbcast:5 row_mask:0xf bank_mask:0xf
    v_and_b32_dpp v21, v33, v9 row_newbcast:5 row_mask:0xf bank_mask:0xf
    v_and_b32_dpp v22, v33, v10 row_newbcast:5 row_mask:0xf bank_mask:0xf
    v_and_b32_dpp v23, v33, v11 row_newbcast:5 row_mask:0xf bank_mask:0xf
    s_waitcnt vmcnt(16)
    buffer_load_dwordx4 v[64:67], v42, s[36:39], s53 offen offset:0 nt
    buffer_load_dwordx4 v[68:71], v42, s[36:39], s53 offen offset:256 nt
    v_mfma_f32_16x16x32_bf16 v[24:27], v[16:19], v[80:83], v[24:27]
    v_mfma_f32_16x16x32_bf16 v[24:27], v[20:23], v[84:87], v[24:27]
    v_and_b32_dpp v16, v33, v8 row_newbcast:9 row_mask:0xf bank_mask:0xf
    v_and_b32_dpp v17, v33, v9 row_newbcast:9 row_mask:0xf bank_mask:0xf
    v_and_b32_dpp v18, v33, v10 row_newbcast:9 row_mask:0xf bank_mask:0xf
    v_and_b32_dpp v19, v33, v11 row_newbcast:9 row_mask:0xf bank_mask:0xf
    v_and_b32_dpp v20, v33, v8 row_newbcast:13 row_mask:0xf bank_mask:0xf
    v_and_b32_dpp v21, v33, v9 row_newbcast:13 row_mask:0xf bank_mask:0xf
    v_and_b32_dpp v22, v33, v10 row_newbcast:13 row_mask:0xf bank_mask:0xf
    v_and_b32_dpp v23, v33, v11 row_newbcast:13 row_mask:0xf bank_mask:0xf
    s_waitcnt vmcnt(16)
    buffer_load_dwordx4 v[72:75], v42, s[36:39], s53 offen offset:512 nt
    buffer_load_dwordx4 v[76:79], v42, s[36:39], s53 offen offset:768 nt
    v_mfma_f32_16x16x32_bf16 v[24:27], v[16:19], v[88:91], v[24:27]
    v_mfma_f32_16x16x32_bf16 v[24:27], v[20:23], v[92:95], v[24:27]
    v_and_b32_dpp v16, v33, v8 row_newbcast:2 row_mask:0xf bank_mask:0xf
    v_and_b32_dpp v17, v33, v9 row_newbcast:2 row_mask:0xf bank_mask:0xf
    v_and_b32_dpp v18, v33, v10 row_newbcast:2 row_mask:0xf bank_mask:0xf
    v_and_b32_dpp v19, v33, v11 row_newbcast:2 row_mask:0xf bank_mask:0xf
    v_and_b32_dpp v20, v33, v8 row_newbcast:6 row_mask:0xf bank_mask:0xf
    v_and_b32_dpp v21, v33, v9 row_newbcast:6 row_mask:0xf bank_mask:0xf
    v_and_b32_dpp v22, v33, v10 row_newbcast:6 row_mask:0xf bank_mask:0xf
    v_and_b32_dpp v23, v33, v11 row_newbcast:6 row_mask:0xf bank_mask:0xf
    s_waitcnt vmcnt(16)
    buffer_load_dwordx4 v[80:83], v43, s[36:39], s53 offen offset:0 nt
    buffer_load_dwordx4 v[84:87], v43, s[36:39], s53 offen offset:256 nt
    v_mfma_f32_16x16x32_bf16 v[24:27], v[16:19], v[96:99], v[24:27]
    v_mfma_f32_16x16x32_bf16 v[24:27], v[20:23], v[100:103], v[24:27]
    v_and_b32_dpp v16, v33, v8 row_newbcast:10 row_mask:0xf bank_mask:0xf
    v_and_b32_dpp v17, v33, v9 row_newbcast:10 row_mask:0xf bank_mask:0xf
    v_and_b32_dpp v18, v33, v10 row_newbcast:10 row_mask:0xf bank_mask:0xf
    v_and_b32_dpp v19, v33, v11 row_newbcast:10 row_mask:0xf bank_mask:0xf
    v_and_b32_dpp v20, v33, v8 row_newbcast:14 row_mask:0xf bank_mask:0xf
    v_and_b32_dpp v21, v33, v9 row_newbcast:14 row_mask:0xf bank_mask:0xf
    v_and_b32_dpp v22, v33, v10 row_newbcast:14 row_mask:0xf bank_mask:0xf
    v_and_b32_dpp v23, v33, v11 row_newbcast:14 row_mask:0xf bank_mask:0xf
    s_waitcnt vmcnt(16)
    buffer_load_dwordx4 v[88:91], v43, s[36:39], s53 offen offset:512 nt
    buffer_load_dwordx4 v[92:95], v43, s[36:39], s53 offen offset:768 nt
    s_add_u32 s68, s53, 4096
    s_xor_b32 s69, s68, s53
    s_and_b32 s69, s69, 65536
    s_add_u32 s53, s68, s69
    v_mfma_f32_16x16x32_bf16 v[24:27], v[16:19], v[104:107], v[24:27]
    v_mfma_f32_16x16x32_bf16 v[24:27], v[20:23], v[108:111], v[24:27]
    v_and_b32_dpp v16, v33, v8 row_newbcast:3 row_mask:0xf bank_mask:0xf
    v_and_b32_dpp v17, v33, v9 row_newbcast:3 row_mask:0xf bank_mask:0xf
    v_and_b32_dpp v18, v33, v10 row_newbcast:3 row_mask:0xf bank_mask:0xf
    v_and_b32_dpp v19, v33, v11 row_newbcast:3 row_mask:0xf bank_mask:0xf
    v_and_b32_dpp v20, v33, v8 row_newbcast:7 row_mask:0xf bank_mask:0xf
    v_and_b32_dpp v21, v33, v9 row_newbcast:7 row_mask:0xf bank_mask:0xf
    v_and_b32_dpp v22, v33, v10 row_newbcast:7 row_mask:0xf bank_mask:0xf
    v_and_b32_dpp v23, v33, v11 row_newbcast:7 row_mask:0xf bank_mask:0xf
    s_waitcnt vmcnt(16)
    buffer_load_dwordx4 v[96:99], v42, s[36:39], s53 offen offset:0 nt
    buffer_load_dwordx4 v[100:103], v42, s[36:39], s53 offen offset:256 nt
    v_mfma_f32_16x16x32_bf16 v[24:27], v[16:19], v[112:115], v[24:27]
    v_mfma_f32_16x16x32_bf16 v[24:27], v[20:23], v[116:119], v[24:27]
    v_and_b32_dpp v16, v33, v8 row_newbcast:11 row_mask:0xf bank_mask:0xf
    v_and_b32_dpp v17, v33, v9 row_newbcast:11 row_mask:0xf bank_mask:0xf
    v_and_b32_dpp v18, v33, v10 row_newbcast:11 row_mask:0xf bank_mask:0xf
    v_and_b32_dpp v19, v33, v11 row_newbcast:11 row_mask:0xf bank_mask:0xf
    v_and_b32_dpp v20, v33, v8 row_newbcast:15 row_mask:0xf bank_mask:0xf
    v_and_b32_dpp v21, v33, v9 row_newbcast:15 row_mask:0xf bank_mask:0xf
    v_and_b32_dpp v22, v33, v10 row_newbcast:15 row_mask:0xf bank_mask:0xf
    v_and_b32_dpp v23, v33, v11 row_newbcast:15 row_mask:0xf bank_mask:0xf
    s_waitcnt vmcnt(16)
    buffer_load_dwordx4 v[104:107], v42, s[36:39], s53 offen offset:512 nt
    buffer_load_dwordx4 v[108:111], v42, s[36:39], s53 offen offset:768 nt
    v_mfma_f32_16x16x32_bf16 v[24:27], v[16:19], v[120:123], v[24:27]
    v_mfma_f32_16x16x32_bf16 v[24:27], v[20:23], v[124:127], v[24:27]
    s_waitcnt lgkmcnt(0)
    v_fma_f32 v31, v30, s55, -v35
    v_exp_f32 v31, v31
    v_add_u32 v38, 512, v38
    ds_read_b32 v30, v38 offset:0
    v_cvt_pk_bf16_f32 v33, v31, v31
    v_add_f32 v36, v36, v31
    s_nop 0
    v_and_b32_dpp v16, v33, v8 row_newbcast:0 row_mask:0xf bank_mask:0xf
    v_and_b32_dpp v17, v33, v9 row_newbcast:0 row_mask:0xf bank_mask:0xf
    v_and_b32_dpp v18, v33, v10 row_newbcast:0 row_mask:0xf bank_mask:0xf
    v_and_b32_dpp v19, v33, v11 row_newbcast:0 row_mask:0xf bank_mask:0xf
    v_and_b32_dpp v20, v33, v8 row_newbcast:4 row_mask:0xf bank_mask:0xf
    v_and_b32_dpp v21, v33, v9 row_newbcast:4 row_mask:0xf bank_mask:0xf
    v_and_b32_dpp v22, v33, v10 row_newbcast:4 row_mask:0xf bank_mask:0xf
    v_and_b32_dpp v23, v33, v11 row_newbcast:4 row_mask:0xf bank_mask:0xf
    s_waitcnt vmcnt(16)
    buffer_load_dwordx4 v[112:115], v43, s[36:39], s53 offen offset:0 nt
    buffer_load_dwordx4 v[116:119], v43, s[36:39], s53 offen offset:256 nt
    v_mfma_f32_16x16x32_bf16 v[24:27], v[16:19], v[128:131], v[24:27]
    v_mfma_f32_16x16x32_bf16 v[24:27], v[20:23], v[132:135], v[24:27]
    v_and_b32_dpp v16, v33, v8 row_newbcast:8 row_mask:0xf bank_mask:0xf
    v_and_b32_dpp v17, v33, v9 row_newbcast:8 row_mask:0xf bank_mask:0xf
    v_and_b32_dpp v18, v33, v10 row_newbcast:8 row_mask:0xf bank_mask:0xf
    v_and_b32_dpp v19, v33, v11 row_newbcast:8 row_mask:0xf bank_mask:0xf
    v_and_b32_dpp v20, v33, v8 row_newbcast:12 row_mask:0xf bank_mask:0xf
    v_and_b32_dpp v21, v33, v9 row_newbcast:12 row_mask:0xf bank_mask:0xf
    v_and_b32_dpp v22, v33, v10 row_newbcast:12 row_mask:0xf bank_mask:0xf
    v_and_b32_dpp v23, v33, v11 row_newbcast:12 row_mask:0xf bank_mask:0xf
    s_waitcnt vmcnt(16)
    buffer_load_dwordx4 v[120:123], v43, s[36:39], s53 offen offset:512 nt
    buffer_load_dwordx4 v[124:127], v43, s[36:39], s53 offen offset:768 nt
    s_add_u32 s68, s53, 4096
    s_xor_b32 s69, s68, s53
    s_and_b32 s69, s69, 65536
    s_add_u32 s53, s68, s69
    v_mfma_f32_16x16x32_bf16 v[24:27], v[16:19], v[136:139], v[24:27]
    v_mfma_f32_16x16x32_bf16 v[24:27], v[20:23], v[140:143], v[24:27]
    v_and_b32_dpp v16, v33, v8 row_newbcast:1 row_mask:0xf bank_mask:0xf
    v_and_b32_dpp v17, v33, v9 row_newbcast:1 row_mask:0xf bank_mask:0xf
    v_and_b32_dpp v18, v33, v10 row_newbcast:1 row_mask:0xf bank_mask:0xf
    v_and_b32_dpp v19, v33, v11 row_newbcast:1 row_mask:0xf bank_mask:0xf
    v_and_b32_dpp v20, v33, v8 row_newbcast:5 row_mask:0xf bank_mask:0xf
    v_and_b32_dpp v21, v33, v9 row_newbcast:5 row_mask:0xf bank_mask:0xf
    v_and_b32_dpp v22, v33, v10 row_newbcast:5 row_mask:0xf bank_mask:0xf
    v_and_b32_dpp v23, v33, v11 row_newbcast:5 row_mask:0xf bank_mask:0xf
    s_waitcnt vmcnt(16)
    buffer_load_dwordx4 v[128:131], v42, s[36:39], s53 offen offset:0 nt
    buffer_load_dwordx4 v[132:135], v42, s[36:39], s53 offen offset:256 nt
    v_mfma_f32_16x16x32_bf16 v[24:27], v[16:19], v[144:147], v[24:27]
    v_mfma_f32_16x16x32_bf16 v[24:27], v[20:23], v[148:151], v[24:27]
    v_and_b32_dpp v16, v33, v8 row_newbcast:9 row_mask:0xf bank_mask:0xf
    v_and_b32_dpp v17, v33, v9 row_newbcast:9 row_mask:0xf bank_mask:0xf
    v_and_b32_dpp v18, v33, v10 row_newbcast:9 row_mask:0xf bank_mask:0xf
    v_and_b32_dpp v19, v33, v11 row_newbcast:9 row_mask:0xf bank_mask:0xf
    v_and_b32_dpp v20, v33, v8 row_newbcast:13 row_mask:0xf bank_mask:0xf
    v_and_b32_dpp v21, v33, v9 row_newbcast:13 row_mask:0xf bank_mask:0xf
    v_and_b32_dpp v22, v33, v10 row_newbcast:13 row_mask:0xf bank_mask:0xf
    v_and_b32_dpp v23, v33, v11 row_newbcast:13 row_mask:0xf bank_mask:0xf
    s_waitcnt vmcnt(16)
    buffer_load_dwordx4 v[136:139], v42, s[36:39], s53 offen offset:512 nt
    buffer_load_dwordx4 v[140:143], v42, s[36:39], s53 offen offset:768 nt
    v_mfma_f32_16x16x32_bf16 v[24:27], v[16:19], v[152:155], v[24:27]
    v_mfma_f32_16x16x32_bf16 v[24:27], v[20:23], v[156:159], v[24:27]
    v_and_b32_dpp v16, v33, v8 row_newbcast:2 row_mask:0xf bank_mask:0xf
    v_and_b32_dpp v17, v33, v9 row_newbcast:2 row_mask:0xf bank_mask:0xf
    v_and_b32_dpp v18, v33, v10 row_newbcast:2 row_mask:0xf bank_mask:0xf
    v_and_b32_dpp v19, v33, v11 row_newbcast:2 row_mask:0xf bank_mask:0xf
    v_and_b32_dpp v20, v33, v8 row_newbcast:6 row_mask:0xf bank_mask:0xf
    v_and_b32_dpp v21, v33, v9 row_newbcast:6 row_mask:0xf bank_mask:0xf
    v_and_b32_dpp v22, v33, v10 row_newbcast:6 row_mask:0xf bank_mask:0xf
    v_and_b32_dpp v23, v33, v11 row_newbcast:6 row_mask:0xf bank_mask:0xf
    s_waitcnt vmcnt(16)
    buffer_load_dwordx4 v[144:147], v43, s[36:39], s53 offen offset:0 nt
    buffer_load_dwordx4 v[148:151], v43, s[36:39], s53 offen offset:256 nt
    v_mfma_f32_16x16x32_bf16 v[24:27], v[16:19], v[160:163], v[24:27]
    v_mfma_f32_16x16x32_bf16 v[24:27], v[20:23], v[164:167], v[24:27]
    v_and_b32_dpp v16, v33, v8 row_newbcast:10 row_mask:0xf bank_mask:0xf
    v_and_b32_dpp v17, v33, v9 row_newbcast:10 row_mask:0xf bank_mask:0xf
    v_and_b32_dpp v18, v33, v10 row_newbcast:10 row_mask:0xf bank_mask:0xf
    v_and_b32_dpp v19, v33, v11 row_newbcast:10 row_mask:0xf bank_mask:0xf
    v_and_b32_dpp v20, v33, v8 row_newbcast:14 row_mask:0xf bank_mask:0xf
    v_and_b32_dpp v21, v33, v9 row_newbcast:14 row_mask:0xf bank_mask:0xf
    v_and_b32_dpp v22, v33, v10 row_newbcast:14 row_mask:0xf bank_mask:0xf
    v_and_b32_dpp v23, v33, v11 row_newbcast:14 row_mask:0xf bank_mask:0xf
    s_waitcnt vmcnt(16)
    buffer_load_dwordx4 v[152:155], v43, s[36:39], s53 offen offset:512 nt
    buffer_load_dwordx4 v[156:159], v43, s[36:39], s53 offen offset:768 nt
    s_add_u32 s68, s53, 4096
    s_xor_b32 s69, s68, s53
    s_and_b32 s69, s69, 65536
    s_add_u32 s53, s68, s69
    v_mfma_f32_16x16x32_bf16 v[24:27], v[16:19], v[168:171], v[24:27]
    v_mfma_f32_16x16x32_bf16 v[24:27], v[20:23], v[172:175], v[24:27]
    v_and_b32_dpp v16, v33, v8 row_newbcast:3 row_mask:0xf bank_mask:0xf
    v_and_b32_dpp v17, v33, v9 row_newbcast:3 row_mask:0xf bank_mask:0xf
    v_and_b32_dpp v18, v33, v10 row_newbcast:3 row_mask:0xf bank_mask:0xf
    v_and_b32_dpp v19, v33, v11 row_newbcast:3 row_mask:0xf bank_mask:0xf
    v_and_b32_dpp v20, v33, v8 row_newbcast:7 row_mask:0xf bank_mask:0xf
    v_and_b32_dpp v21, v33, v9 row_newbcast:7 row_mask:0xf bank_mask:0xf
    v_and_b32_dpp v22, v33, v10 row_newbcast:7 row_mask:0xf bank_mask:0xf
    v_and_b32_dpp v23, v33, v11 row_newbcast:7 row_mask:0xf bank_mask:0xf
    s_waitcnt vmcnt(16)
    buffer_load_dwordx4 v[160:163], v42, s[36:39], s53 offen offset:0 nt
    buffer_load_dwordx4 v[164:167], v42, s[36:39], s53 offen offset:256 nt
    v_mfma_f32_16x16x32_bf16 v[24:27], v[16:19], v[176:179], v[24:27]
    v_mfma_f32_16x16x32_bf16 v[24:27], v[20:23], v[180:183], v[24:27]
    v_and_b32_dpp v16, v33, v8 row_newbcast:11 row_mask:0xf bank_mask:0xf
    v_and_b32_dpp v17, v33, v9 row_newbcast:11 row_mask:0xf bank_mask:0xf
    v_and_b32_dpp v18, v33, v10 row_newbcast:11 row_mask:0xf bank_mask:0xf
    v_and_b32_dpp v19, v33, v11 row_newbcast:11 row_mask:0xf bank_mask:0xf
    v_and_b32_dpp v20, v33, v8 row_newbcast:15 row_mask:0xf bank_mask:0xf
    v_and_b32_dpp v21, v33, v9 row_newbcast:15 row_mask:0xf bank_mask:0xf
    v_and_b32_dpp v22, v33, v10 row_newbcast:15 row_mask:0xf bank_mask:0xf
    v_and_b32_dpp v23, v33, v11 row_newbcast:15 row_mask:0xf bank_mask:0xf
    s_waitcnt vmcnt(16)
    buffer_load_dwordx4 v[168:171], v42, s[36:39], s53 offen offset:512 nt
    buffer_load_dwordx4 v[172:175], v42, s[36:39], s53 offen offset:768 nt
    v_mfma_f32_16x16x32_bf16 v[24:27], v[16:19], v[184:187], v[24:27]
    v_mfma_f32_16x16x32_bf16 v[24:27], v[20:23], v[188:191], v[24:27]
    s_waitcnt lgkmcnt(0)
    v_fma_f32 v31, v30, s55, -v35
    v_exp_f32 v31, v31
    ds_read_b32 v30, v38 offset:256
    v_cvt_pk_bf16_f32 v33, v31, v31
    v_add_f32 v36, v36, v31
    s_nop 0
    v_and_b32_dpp v16, v33, v8 row_newbcast:0 row_mask:0xf bank_mask:0xf
    v_and_b32_dpp v17, v33, v9 row_newbcast:0 row_mask:0xf bank_mask:0xf
    v_and_b32_dpp v18, v33, v10 row_newbcast:0 row_mask:0xf bank_mask:0xf
    v_and_b32_dpp v19, v33, v11 row_newbcast:0 row_mask:0xf bank_mask:0xf
    v_and_b32_dpp v20, v33, v8 row_newbcast:4 row_mask:0xf bank_mask:0xf
    v_and_b32_dpp v21, v33, v9 row_newbcast:4 row_mask:0xf bank_mask:0xf
    v_and_b32_dpp v22, v33, v10 row_newbcast:4 row_mask:0xf bank_mask:0xf
    v_and_b32_dpp v23, v33, v11 row_newbcast:4 row_mask:0xf bank_mask:0xf
    s_branch L_Vdisp
L_HA_noq:
    s_waitcnt lgkmcnt(0)
    s_load_dword s88, s[28:29], 0
    s_mov_b32 s48, s28
    s_mov_b32 s49, s29
    s_mov_b32 s50, 2097152
    s_mov_b32 s51, 0x20000
    s_mov_b32 s36, s4
    s_mov_b32 s37, s5
    s_mov_b32 s38, 9216
    s_mov_b32 s39, 0x20000
    v_and_b32 v5, 7, v0
    v_mul_u32_u24 v9, 1152, v5
    v_lshrrev_b32 v8, 4, v0
    v_lshl_add_u32 v9, v8, 4, v9
    s_mov_b32 s44, s12
    s_mov_b32 s45, s13
    s_mov_b32 s46, 4718592
    s_mov_b32 s47, 0x20000
    v_lshrrev_b32 v4, 3, v0
    v_mul_u32_u24 v4, 1152, v4
    v_lshl_add_u32 v4, v5, 4, v4
    s_and_b32 s68, s2, 7
    s_bfe_u32 s69, s2, 0x10003
    s_lshl_b32 s69, s69, 4
    s_add_u32 s68, s68, s69
    s_mul_i32 s75, s68, 147456
    s_lshr_b32 s69, s2, 4
    s_lshl_b32 s69, s69, 7
    s_add_u32 s75, s75, s69
    s_add_u32 s77, s75, 1179648
    s_cmp_lt_u32 s2, 40
    s_cselect_b32 s78, 36864, 0
    s_add_u32 m0, s78, 0
    s_waitcnt vmcnt(9)
    buffer_load_dwordx4 v4, s[44:47], s75 offen nt lds
    s_add_u32 s75, s75, 9216
    s_add_u32 m0, s78, 1024
    s_waitcnt vmcnt(9)
    buffer_load_dwordx4 v4, s[44:47], s75 offen nt lds
    s_add_u32 s75, s75, 9216
    s_add_u32 m0, s78, 2048
    s_waitcnt vmcnt(9)
    buffer_load_dwordx4 v4, s[44:47], s75 offen nt lds
    s_add_u32 s75, s75, 9216
    s_add_u32 m0, s78, 3072
    s_waitcnt vmcnt(9)
    buffer_load_dwordx4 v4, s[44:47], s75 offen nt lds
    s_add_u32 s75, s75, 9216
    s_add_u32 m0, s78, 4096
    s_waitcnt vmcnt(9)
    buffer_load_dwordx4 v4, s[44:47], s75 offen nt lds
    s_add_u32 s75, s75, 9216
    s_add_u32 m0, s78, 5120
    s_waitcnt vmcnt(9)
    buffer_load_dwordx4 v4, s[44:47], s75 offen nt lds
    s_add_u32 s75, s75, 9216
    s_add_u32 m0, s78, 6144
    s_waitcnt vmcnt(9)
    buffer_load_dwordx4 v4, s[44:47], s75 offen nt lds
    s_add_u32 s75, s75, 9216
    s_add_u32 m0, s78, 7168
    s_waitcnt vmcnt(9)
    buffer_load_dwordx4 v4, s[44:47], s75 offen nt lds
    s_add_u32 s75, s75, 9216
    s_add_u32 m0, s78, 8192
    s_waitcnt vmcnt(9)
    buffer_load_dwordx4 v4, s[44:47], s75 offen nt lds
    s_add_u32 s75, s75, 9216
    s_add_u32 m0, s78, 9216
    s_waitcnt vmcnt(9)
    buffer_load_dwordx4 v4, s[44:47], s75 offen nt lds
    s_add_u32 s75, s75, 9216
    s_add_u32 m0, s78, 10240
    s_waitcnt vmcnt(9)
    buffer_load_dwordx4 v4, s[44:47], s75 offen nt lds
    s_add_u32 s75, s75, 9216
    s_add_u32 m0, s78, 11264
    s_waitcnt vmcnt(9)
    buffer_load_dwordx4 v4, s[44:47], s75 offen nt lds
    s_add_u32 s75, s75, 9216
    s_add_u32 m0, s78, 12288
    s_waitcnt vmcnt(9)
    buffer_load_dwordx4 v4, s[44:47], s75 offen nt lds
    s_add_u32 s75, s75, 9216
    s_add_u32 m0, s78, 13312
    s_waitcnt vmcnt(9)
    buffer_load_dwordx4 v4, s[44:47], s75 offen nt lds
    s_add_u32 s75, s75, 9216
    s_add_u32 m0, s78, 14336
    s_waitcnt vmcnt(9)
    buffer_load_dwordx4 v4, s[44:47], s75 offen nt lds
    s_add_u32 s75, s75, 9216
    s_add_u32 m0, s78, 15360
    s_waitcnt vmcnt(9)
    buffer_load_dwordx4 v4, s[44:47], s75 offen nt lds
    s_add_u32 s75, s75, 9216
    s_add_u32 m0, s78, 16384
    s_waitcnt vmcnt(9)
    buffer_load_dwordx4 v4, s[44:47], s77 offen nt lds
    s_add_u32 s77, s77, 9216
    s_add_u32 m0, s78, 17408
    s_waitcnt vmcnt(9)
    buffer_load_dwordx4 v4, s[44:47], s77 offen nt lds
    s_add_u32 s77, s77, 9216
    s_add_u32 m0, s78, 18432
    s_waitcnt vmcnt(9)
    buffer_load_dwordx4 v4, s[44:47], s77 offen nt lds
    s_add_u32 s77, s77, 9216
    s_add_u32 m0, s78, 19456
    s_waitcnt vmcnt(9)
    buffer_load_dwordx4 v4, s[44:47], s77 offen nt lds
    s_add_u32 s77, s77, 9216
    s_add_u32 m0, s78, 20480
    s_waitcnt vmcnt(9)
    buffer_load_dwordx4 v4, s[44:47], s77 offen nt lds
    s_add_u32 s77, s77, 9216
    s_add_u32 m0, s78, 21504
    s_waitcnt vmcnt(9)
    buffer_load_dwordx4 v4, s[44:47], s77 offen nt lds
    s_add_u32 s77, s77, 9216
    s_add_u32 m0, s78, 22528
    s_waitcnt vmcnt(9)
    buffer_load_dwordx4 v4, s[44:47], s77 offen nt lds
    s_add_u32 s77, s77, 9216
    s_add_u32 m0, s78, 23552
    s_waitcnt vmcnt(9)
    buffer_load_dwordx4 v4, s[44:47], s77 offen nt lds
    s_add_u32 s77, s77, 9216
    s_add_u32 m0, s78, 24576
    s_waitcnt vmcnt(9)
    buffer_load_dwordx4 v4, s[44:47], s77 offen nt lds
    s_add_u32 s77, s77, 9216
    s_add_u32 m0, s78, 25600
    s_waitcnt vmcnt(9)
    buffer_load_dwordx4 v4, s[44:47], s77 offen nt lds
    s_add_u32 s77, s77, 9216
    s_add_u32 m0, s78, 26624
    s_waitcnt vmcnt(9)
    buffer_load_dwordx4 v4, s[44:47], s77 offen nt lds
    s_add_u32 s77, s77, 9216
    s_add_u32 m0, s78, 27648
    s_waitcnt vmcnt(9)
    buffer_load_dwordx4 v4, s[44:47], s77 offen nt lds
    s_add_u32 s77, s77, 9216
    s_add_u32 m0, s78, 28672
    s_waitcnt vmcnt(9)
    buffer_load_dwordx4 v4, s[44:47], s77 offen nt lds
    s_add_u32 s77, s77, 9216
    s_add_u32 m0, s78, 29696
    s_waitcnt vmcnt(9)
    buffer_load_dwordx4 v4, s[44:47], s77 offen nt lds
    s_add_u32 s77, s77, 9216
    s_add_u32 m0, s78, 30720
    s_waitcnt vmcnt(9)
    buffer_load_dwordx4 v4, s[44:47], s77 offen nt lds
    s_add_u32 s77, s77, 9216
    s_add_u32 m0, s78, 31744
    s_waitcnt vmcnt(9)
    buffer_load_dwordx4 v4, s[44:47], s77 offen nt lds
    s_add_u32 s77, s77, 9216
    v_lshrrev_b32 v6, 4, v0
    v_mul_u32_u24 v6, 8, v6
    v_bfe_u32 v10, v0, 2, 2
    v_add_u32 v6, v6, v10
    v_mul_u32_u24 v6, 128, v6
    v_and_b32 v10, 3, v0
    v_mul_u32_u24 v10, 16, v10
    v_add_u32 v6, v6, v10
    v_and_b32 v10, 8, v0
    v_lshlrev_b32 v12, 1, v10
    v_lshl_add_u32 v12, v8, 5, v12
    v_cmp_ne_u32 s[66:67], 0, v10
    s_waitcnt lgkmcnt(0)
    s_mul_i32 s89, s88, 0x9E3779B1
    s_add_u32 s89, s89, 0x7F4A7C15
    s_add_u32 s88, s88, 1
    s_add_u32 s63, s88, 0
    s_and_b32 s63, s63, 0xff
    v_mov_b32 v60, s63
    s_add_u32 s63, s88, 85
    s_and_b32 s63, s63, 0xff
    v_mov_b32 v61, s63
    s_add_u32 s63, s88, 170
    s_and_b32 s63, s63, 0xff
    v_mov_b32 v62, s63
    s_add_u32 s63, s88, 51
    s_and_b32 s63, s63, 0xff
    v_mov_b32 v63, s63
    s_mov_b32 s59, 0xffffff00
    s_waitcnt vmcnt(0)
    s_branch L_HA2
L_HA_fin:
    s_barrier
    s_branch L_FIN
L_HA2:
    s_setprio 0
    s_barrier
    s_cmp_ge_u32 s2, 184
    s_cbranch_scc1 L_FFN2
    s_cmp_lt_u32 s2, 40
    s_cbranch_scc1 L_HA_fin
    buffer_load_dwordx4 v[72:75], v9, s[36:39], 0 offen offset:0
    buffer_load_dwordx4 v[76:79], v9, s[36:39], 0 offen offset:64
    buffer_load_dwordx4 v[80:83], v9, s[36:39], 0 offen offset:128
    buffer_load_dwordx4 v[84:87], v9, s[36:39], 0 offen offset:192
    s_waitcnt vmcnt(3)
    buffer_load_dwordx4 v[88:91], v9, s[36:39], 0 offen offset:256
    s_waitcnt vmcnt(3)
    buffer_load_dwordx4 v[92:95], v9, s[36:39], 0 offen offset:320
    s_waitcnt vmcnt(3)
    buffer_load_dwordx4 v[96:99], v9, s[36:39], 0 offen offset:384
    s_waitcnt vmcnt(3)
    buffer_load_dwordx4 v[100:103], v9, s[36:39], 0 offen offset:448
    s_waitcnt vmcnt(3)
    buffer_load_dwordx4 v[104:107], v9, s[36:39], 0 offen offset:512
    s_waitcnt vmcnt(3)
    buffer_load_dwordx4 v[108:111], v9, s[36:39], 0 offen offset:576
    s_waitcnt vmcnt(3)
    buffer_load_dwordx4 v[112:115], v9, s[36:39], 0 offen offset:640
    s_waitcnt vmcnt(3)
    buffer_load_dwordx4 v[116:119], v9, s[36:39], 0 offen offset:704
    s_waitcnt vmcnt(3)
    buffer_load_dwordx4 v[120:123], v9, s[36:39], 0 offen offset:768
    s_waitcnt vmcnt(3)
    buffer_load_dwordx4 v[124:127], v9, s[36:39], 0 offen offset:832
    s_waitcnt vmcnt(3)
    buffer_load_dwordx4 v[128:131], v9, s[36:39], 0 offen offset:896
    s_waitcnt vmcnt(3)
    buffer_load_dwordx4 v[132:135], v9, s[36:39], 0 offen offset:960
    s_waitcnt vmcnt(3)
    buffer_load_dwordx4 v[136:139], v9, s[36:39], 0 offen offset:1024
    s_waitcnt vmcnt(3)
    buffer_load_dwordx4 v[140:143], v9, s[36:39], 0 offen offset:1088
L_FFN1x:
    v_add_u32 v6, 36864, v6
    v_add_u32 v7, 36864, v6
    v_mul_u32_u24 v11, 18432, v5
    v_add_u32 v11, v11, v12
    s_cmp_lt_u32 s2, 112
    s_cselect_b32 s52, 40, 112
    s_sub_u32 s52, s2, s52
    s_lshr_b32 s52, s52, 3
    s_and_b32 s53, s2, 7
    s_mul_i32 s53, s53, 9
    s_add_u32 s52, s52, s53
    s_lshl_b32 s52, s52, 8
    s_add_u32 s57, s52, 851968
    v_mov_b32 v13, 143624
    s_waitcnt vmcnt(0)
    ds_read_b64_tr_b16 v[144:145], v6 offset:0
    ds_read_b64_tr_b16 v[146:147], v6 offset:512
    ds_read_b64_tr_b16 v[148:149], v6 offset:8
    ds_read_b64_tr_b16 v[150:151], v6 offset:520
    ds_read_b64_tr_b16 v[152:153], v6 offset:64
    ds_read_b64_tr_b16 v[154:155], v6 offset:576
    ds_read_b64_tr_b16 v[156:157], v6 offset:72
    ds_read_b64_tr_b16 v[158:159], v6 offset:584
    ds_read_b64_tr_b16 v[160:161], v6 offset:4096
    ds_read_b64_tr_b16 v[162:163], v6 offset:4608
    ds_read_b64_tr_b16 v[164:165], v6 offset:4104
    ds_read_b64_tr_b16 v[166:167], v6 offset:4616
    ds_read_b64_tr_b16 v[168:169], v6 offset:4160
    ds_read_b64_tr_b16 v[170:171], v6 offset:4672
    ds_read_b64_tr_b16 v[172:173], v6 offset:4168
    ds_read_b64_tr_b16 v[174:175], v6 offset:4680
    s_waitcnt lgkmcnt(8)
    v_mfma_f32_16x16x32_bf16 v[16:19], v[144:147], v[72:75], 0
    v_mfma_f32_16x16x32_bf16 v[20:23], v[148:151], v[72:75], 0
    v_mfma_f32_16x16x32_bf16 v[24:27], v[152:155], v[72:75], 0
    v_mfma_f32_16x16x32_bf16 v[28:31], v[156:159], v[72:75], 0
    ds_read_b64_tr_b16 v[144:145], v6 offset:8192
    ds_read_b64_tr_b16 v[146:147], v6 offset:8704
    ds_read_b64_tr_b16 v[148:149], v6 offset:8200
    ds_read_b64_tr_b16 v[150:151], v6 offset:8712
    ds_read_b64_tr_b16 v[152:153], v6 offset:8256
    ds_read_b64_tr_b16 v[154:155], v6 offset:8768
    ds_read_b64_tr_b16 v[156:157], v6 offset:8264
    ds_read_b64_tr_b16 v[158:159], v6 offset:8776
    s_waitcnt lgkmcnt(8)
    v_mfma_f32_16x16x32_bf16 v[16:19], v[160:163], v[76:79], v[16:19]
    v_mfma_f32_16x16x32_bf16 v[20:23], v[164:167], v[76:79], v[20:23]
    v_mfma_f32_16x16x32_bf16 v[24:27], v[168:171], v[76:79], v[24:27]
    v_mfma_f32_16x16x32_bf16 v[28:31], v[172:175], v[76:79], v[28:31]
    ds_read_b64_tr_b16 v[160:161], v6 offset:12288
    ds_read_b64_tr_b16 v[162:163], v6 offset:12800
    ds_read_b64_tr_b16 v[164:165], v6 offset:12296
    ds_read_b64_tr_b16 v[166:167], v6 offset:12808
    ds_read_b64_tr_b16 v[168:169], v6 offset:12352
    ds_read_b64_tr_b16 v[170:171], v6 offset:12864
    ds_read_b64_tr_b16 v[172:173], v6 offset:12360
    ds_read_b64_tr_b16 v[174:175], v6 offset:12872
    s_waitcnt lgkmcnt(8)
    v_mfma_f32_16x16x32_bf16 v[16:19], v[144:147], v[80:83], v[16:19]
    v_mfma_f32_16x16x32_bf16 v[20:23], v[148:151], v[80:83], v[20:23]
    v_mfma_f32_16x16x32_bf16 v[24:27], v[152:155], v[80:83], v[24:27]
    v_mfma_f32_16x16x32_bf16 v[28:31], v[156:159], v[80:83], v[28:31]
    ds_read_b64_tr_b16 v[144:145], v6 offset:16384
    ds_read_b64_tr_b16 v[146:147], v6 offset:16896
    ds_read_b64_tr_b16 v[148:149], v6 offset:16392
    ds_read_b64_tr_b16 v[150:151], v6 offset:16904
    ds_read_b64_tr_b16 v[152:153], v6 offset:16448
    ds_read_b64_tr_b16 v[154:155], v6 offset:16960
    ds_read_b64_tr_b16 v[156:157], v6 offset:16456
    ds_read_b64_tr_b16 v[158:159], v6 offset:16968
    s_waitcnt lgkmcnt(8)
    v_mfma_f32_16x16x32_bf16 v[16:19], v[160:163], v[84:87], v[16:19]
    v_mfma_f32_16x16x32_bf16 v[20:23], v[164:167], v[84:87], v[20:23]
    v_mfma_f32_16x16x32_bf16 v[24:27], v[168:171], v[84:87], v[24:27]
    v_mfma_f32_16x16x32_bf16 v[28:31], v[172:175], v[84:87], v[28:31]
    ds_read_b64_tr_b16 v[160:161], v6 offset:20480
    ds_read_b64_tr_b16 v[162:163], v6 offset:20992
    ds_read_b64_tr_b16 v[164:165], v6 offset:20488
    ds_read_b64_tr_b16 v[166:167], v6 offset:21000
    ds_read_b64_tr_b16 v[168:169], v6 offset:20544
    ds_read_b64_tr_b16 v[170:171], v6 offset:21056
    ds_read_b64_tr_b16 v[172:173], v6 offset:20552
    ds_read_b64_tr_b16 v[174:175], v6 offset:21064
    s_waitcnt lgkmcnt(8)
    v_mfma_f32_16x16x32_bf16 v[16:19], v[144:147], v[88:91], v[16:19]
    v_mfma_f32_16x16x32_bf16 v[20:23], v[148:151], v[88:91], v[20:23]
    v_mfma_f32_16x16x32_bf16 v[24:27], v[152:155], v[88:91], v[24:27]
    v_mfma_f32_16x16x32_bf16 v[28:31], v[156:159], v[88:91], v[28:31]
    ds_read_b64_tr_b16 v[144:145], v6 offset:24576
    ds_read_b64_tr_b16 v[146:147], v6 offset:25088
    ds_read_b64_tr_b16 v[148:149], v6 offset:24584
    ds_read_b64_tr_b16 v[150:151], v6 offset:25096
    ds_read_b64_tr_b16 v[152:153], v6 offset:24640
    ds_read_b64_tr_b16 v[154:155], v6 offset:25152
    ds_read_b64_tr_b16 v[156:157], v6 offset:24648
    ds_read_b64_tr_b16 v[158:159], v6 offset:25160
    s_waitcnt lgkmcnt(8)
    v_mfma_f32_16x16x32_bf16 v[16:19], v[160:163], v[92:95], v[16:19]
    v_mfma_f32_16x16x32_bf16 v[20:23], v[164:167], v[92:95], v[20:23]
    v_mfma_f32_16x16x32_bf16 v[24:27], v[168:171], v[92:95], v[24:27]
    v_mfma_f32_16x16x32_bf16 v[28:31], v[172:175], v[92:95], v[28:31]
    ds_read_b64_tr_b16 v[160:161], v6 offset:28672
    ds_read_b64_tr_b16 v[162:163], v6 offset:29184
    ds_read_b64_tr_b16 v[164:165], v6 offset:28680
    ds_read_b64_tr_b16 v[166:167], v6 offset:29192
    ds_read_b64_tr_b16 v[168:169], v6 offset:28736
    ds_read_b64_tr_b16 v[170:171], v6 offset:29248
    ds_read_b64_tr_b16 v[172:173], v6 offset:28744
    ds_read_b64_tr_b16 v[174:175], v6 offset:29256
    s_waitcnt lgkmcnt(8)
    v_mfma_f32_16x16x32_bf16 v[16:19], v[144:147], v[96:99], v[16:19]
    v_mfma_f32_16x16x32_bf16 v[20:23], v[148:151], v[96:99], v[20:23]
    v_mfma_f32_16x16x32_bf16 v[24:27], v[152:155], v[96:99], v[24:27]
    v_mfma_f32_16x16x32_bf16 v[28:31], v[156:159], v[96:99], v[28:31]
    ds_read_b64_tr_b16 v[144:145], v6 offset:32768
    ds_read_b64_tr_b16 v[146:147], v6 offset:33280
    ds_read_b64_tr_b16 v[148:149], v6 offset:32776
    ds_read_b64_tr_b16 v[150:151], v6 offset:33288
    ds_read_b64_tr_b16 v[152:153], v6 offset:32832
    ds_read_b64_tr_b16 v[154:155], v6 offset:33344
    ds_read_b64_tr_b16 v[156:157], v6 offset:32840
    ds_read_b64_tr_b16 v[158:159], v6 offset:33352
    s_waitcnt lgkmcnt(8)
    v_mfma_f32_16x16x32_bf16 v[16:19], v[160:163], v[100:103], v[16:19]
    v_mfma_f32_16x16x32_bf16 v[20:23], v[164:167], v[100:103], v[20:23]
    v_mfma_f32_16x16x32_bf16 v[24:27], v[168:171], v[100:103], v[24:27]
    v_mfma_f32_16x16x32_bf16 v[28:31], v[172:175], v[100:103], v[28:31]
    ds_read_b64_tr_b16 v[160:161], v7 offset:0
    ds_read_b64_tr_b16 v[162:163], v7 offset:512
    ds_read_b64_tr_b16 v[164:165], v7 offset:8
    ds_read_b64_tr_b16 v[166:167], v7 offset:520
    ds_read_b64_tr_b16 v[168:169], v7 offset:64
    ds_read_b64_tr_b16 v[170:171], v7 offset:576
    ds_read_b64_tr_b16 v[172:173], v7 offset:72
    ds_read_b64_tr_b16 v[174:175], v7 offset:584
    s_waitcnt lgkmcnt(8)
    v_mfma_f32_16x16x32_bf16 v[16:19], v[144:147], v[104:107], v[16:19]
    v_mfma_f32_16x16x32_bf16 v[20:23], v[148:151], v[104:107], v[20:23]
    v_mfma_f32_16x16x32_bf16 v[24:27], v[152:155], v[104:107], v[24:27]
    v_mfma_f32_16x16x32_bf16 v[28:31], v[156:159], v[104:107], v[28:31]
    ds_read_b64_tr_b16 v[144:145], v7 offset:4096
    ds_read_b64_tr_b16 v[146:147], v7 offset:4608
    ds_read_b64_tr_b16 v[148:149], v7 offset:4104
    ds_read_b64_tr_b16 v[150:151], v7 offset:4616
    ds_read_b64_tr_b16 v[152:153], v7 offset:4160
    ds_read_b64_tr_b16 v[154:155], v7 offset:4672
    ds_read_b64_tr_b16 v[156:157], v7 offset:4168
    ds_read_b64_tr_b16 v[158:159], v7 offset:4680
    s_waitcnt lgkmcnt(8)
    v_mfma_f32_16x16x32_bf16 v[16:19], v[160:163], v[108:111], v[16:19]
    v_mfma_f32_16x16x32_bf16 v[20:23], v[164:167], v[108:111], v[20:23]
    v_mfma_f32_16x16x32_bf16 v[24:27], v[168:171], v[108:111], v[24:27]
    v_mfma_f32_16x16x32_bf16 v[28:31], v[172:175], v[108:111], v[28:31]
    ds_read_b64_tr_b16 v[160:161], v7 offset:8192
    ds_read_b64_tr_b16 v[162:163], v7 offset:8704
    ds_read_b64_tr_b16 v[164:165], v7 offset:8200
    ds_read_b64_tr_b16 v[166:167], v7 offset:8712
    ds_read_b64_tr_b16 v[168:169], v7 offset:8256
    ds_read_b64_tr_b16 v[170:171], v7 offset:8768
    ds_read_b64_tr_b16 v[172:173], v7 offset:8264
    ds_read_b64_tr_b16 v[174:175], v7 offset:8776
    s_waitcnt lgkmcnt(8)
    v_mfma_f32_16x16x32_bf16 v[16:19], v[144:147], v[112:115], v[16:19]
    v_mfma_f32_16x16x32_bf16 v[20:23], v[148:151], v[112:115], v[20:23]
    v_mfma_f32_16x16x32_bf16 v[24:27], v[152:155], v[112:115], v[24:27]
    v_mfma_f32_16x16x32_bf16 v[28:31], v[156:159], v[112:115], v[28:31]
    ds_read_b64_tr_b16 v[144:145], v7 offset:12288
    ds_read_b64_tr_b16 v[146:147], v7 offset:12800
    ds_read_b64_tr_b16 v[148:149], v7 offset:12296
    ds_read_b64_tr_b16 v[150:151], v7 offset:12808
    ds_read_b64_tr_b16 v[152:153], v7 offset:12352
    ds_read_b64_tr_b16 v[154:155], v7 offset:12864
    ds_read_b64_tr_b16 v[156:157], v7 offset:12360
    ds_read_b64_tr_b16 v[158:159], v7 offset:12872
    s_waitcnt lgkmcnt(8)
    v_mfma_f32_16x16x32_bf16 v[16:19], v[160:163], v[116:119], v[16:19]
    v_mfma_f32_16x16x32_bf16 v[20:23], v[164:167], v[116:119], v[20:23]
    v_mfma_f32_16x16x32_bf16 v[24:27], v[168:171], v[116:119], v[24:27]
    v_mfma_f32_16x16x32_bf16 v[28:31], v[172:175], v[116:119], v[28:31]
    ds_read_b64_tr_b16 v[160:161], v7 offset:16384
    ds_read_b64_tr_b16 v[162:163], v7 offset:16896
    ds_read_b64_tr_b16 v[164:165], v7 offset:16392
    ds_read_b64_tr_b16 v[166:167], v7 offset:16904
    ds_read_b64_tr_b16 v[168:169], v7 offset:16448
    ds_read_b64_tr_b16 v[170:171], v7 offset:16960
    ds_read_b64_tr_b16 v[172:173], v7 offset:16456
    ds_read_b64_tr_b16 v[174:175], v7 offset:16968
    s_waitcnt lgkmcnt(8)
    v_mfma_f32_16x16x32_bf16 v[16:19], v[144:147], v[120:123], v[16:19]
    v_mfma_f32_16x16x32_bf16 v[20:23], v[148:151], v[120:123], v[20:23]
    v_mfma_f32_16x16x32_bf16 v[24:27], v[152:155], v[120:123], v[24:27]
    v_mfma_f32_16x16x32_bf16 v[28:31], v[156:159], v[120:123], v[28:31]
    ds_read_b64_tr_b16 v[144:145], v7 offset:20480
    ds_read_b64_tr_b16 v[146:147], v7 offset:20992
    ds_read_b64_tr_b16 v[148:149], v7 offset:20488
    ds_read_b64_tr_b16 v[150:151], v7 offset:21000
    ds_read_b64_tr_b16 v[152:153], v7 offset:20544
    ds_read_b64_tr_b16 v[154:155], v7 offset:21056
    ds_read_b64_tr_b16 v[156:157], v7 offset:20552
    ds_read_b64_tr_b16 v[158:159], v7 offset:21064
    s_waitcnt lgkmcnt(8)
    v_mfma_f32_16x16x32_bf16 v[16:19], v[160:163], v[124:127], v[16:19]
    v_mfma_f32_16x16x32_bf16 v[20:23], v[164:167], v[124:127], v[20:23]
    v_mfma_f32_16x16x32_bf16 v[24:27], v[168:171], v[124:127], v[24:27]
    v_mfma_f32_16x16x32_bf16 v[28:31], v[172:175], v[124:127], v[28:31]
    ds_read_b64_tr_b16 v[160:161], v7 offset:24576
    ds_read_b64_tr_b16 v[162:163], v7 offset:25088
    ds_read_b64_tr_b16 v[164:165], v7 offset:24584
    ds_read_b64_tr_b16 v[166:167], v7 offset:25096
    ds_read_b64_tr_b16 v[168:169], v7 offset:24640
    ds_read_b64_tr_b16 v[170:171], v7 offset:25152
    ds_read_b64_tr_b16 v[172:173], v7 offset:24648
    ds_read_b64_tr_b16 v[174:175], v7 offset:25160
    s_waitcnt lgkmcnt(8)
    v_mfma_f32_16x16x32_bf16 v[16:19], v[144:147], v[128:131], v[16:19]
    v_mfma_f32_16x16x32_bf16 v[20:23], v[148:151], v[128:131], v[20:23]
    v_mfma_f32_16x16x32_bf16 v[24:27], v[152:155], v[128:131], v[24:27]
    v_mfma_f32_16x16x32_bf16 v[28:31], v[156:159], v[128:131], v[28:31]
    ds_read_b64_tr_b16 v[144:145], v7 offset:28672
    ds_read_b64_tr_b16 v[146:147], v7 offset:29184
    ds_read_b64_tr_b16 v[148:149], v7 offset:28680
    ds_read_b64_tr_b16 v[150:151], v7 offset:29192
    ds_read_b64_tr_b16 v[152:153], v7 offset:28736
    ds_read_b64_tr_b16 v[154:155], v7 offset:29248
    ds_read_b64_tr_b16 v[156:157], v7 offset:28744
    ds_read_b64_tr_b16 v[158:159], v7 offset:29256
    s_waitcnt lgkmcnt(8)
    v_mfma_f32_16x16x32_bf16 v[16:19], v[160:163], v[132:135], v[16:19]
    v_mfma_f32_16x16x32_bf16 v[20:23], v[164:167], v[132:135], v[20:23]
    v_mfma_f32_16x16x32_bf16 v[24:27], v[168:171], v[132:135], v[24:27]
    v_mfma_f32_16x16x32_bf16 v[28:31], v[172:175], v[132:135], v[28:31]
    ds_read_b64_tr_b16 v[160:161], v7 offset:32768
    ds_read_b64_tr_b16 v[162:163], v7 offset:33280
    ds_read_b64_tr_b16 v[164:165], v7 offset:32776
    ds_read_b64_tr_b16 v[166:167], v7 offset:33288
    ds_read_b64_tr_b16 v[168:169], v7 offset:32832
    ds_read_b64_tr_b16 v[170:171], v7 offset:33344
    ds_read_b64_tr_b16 v[172:173], v7 offset:32840
    ds_read_b64_tr_b16 v[174:175], v7 offset:33352
    s_waitcnt lgkmcnt(8)
    v_mfma_f32_16x16x32_bf16 v[16:19], v[144:147], v[136:139], v[16:19]
    v_mfma_f32_16x16x32_bf16 v[20:23], v[148:151], v[136:139], v[20:23]
    v_mfma_f32_16x16x32_bf16 v[24:27], v[152:155], v[136:139], v[24:27]
    v_mfma_f32_16x16x32_bf16 v[28:31], v[156:159], v[136:139], v[28:31]
    s_waitcnt lgkmcnt(0)
    v_mfma_f32_16x16x32_bf16 v[16:19], v[160:163], v[140:143], v[16:19]
    v_mfma_f32_16x16x32_bf16 v[20:23], v[164:167], v[140:143], v[20:23]
    v_mfma_f32_16x16x32_bf16 v[24:27], v[168:171], v[140:143], v[24:27]
    v_mfma_f32_16x16x32_bf16 v[28:31], v[172:175], v[140:143], v[28:31]
    s_cmp_ge_u32 s2, 112
    s_cbranch_scc1 L_UP
    ds_read_b32 v3, v13
    s_waitcnt lgkmcnt(0)
    v_readfirstlane_b32 s64, v3
    s_nop 6
    v_cndmask_b32 v64, v16, v20, s[66:67]
    v_cndmask_b32 v65, v17, v21, s[66:67]
    v_cndmask_b32 v66, v18, v22, s[66:67]
    v_cndmask_b32 v67, v19, v23, s[66:67]
    v_cndmask_b32 v68, v24, v28, s[66:67]
    v_cndmask_b32 v69, v25, v29, s[66:67]
    v_cndmask_b32 v70, v26, v30, s[66:67]
    v_cndmask_b32 v71, v27, v31, s[66:67]
    v_bfi_b32 v64, s59, v64, v60
    v_bfi_b32 v65, s59, v65, v61
    v_bfi_b32 v66, s59, v66, v62
    v_bfi_b32 v67, s59, v67, v63
    v_bfi_b32 v68, s59, v68, v60
    v_bfi_b32 v69, s59, v69, v61
    v_bfi_b32 v70, s59, v70, v62
    v_bfi_b32 v71, s59, v71, v63
    s_cmp_eq_u32 s64, 1
    s_cbranch_scc1 L_ploc_3
    buffer_store_dwordx4 v[64:67], v11, s[48:51], s57 offen offset:0 sc1
    buffer_store_dwordx4 v[68:71], v11, s[48:51], s57 offen offset:128 sc1
    s_branch L_pdn_4
L_ploc_3:
    buffer_store_dwordx4 v[64:67], v11, s[48:51], s57 offen offset:0
    buffer_store_dwordx4 v[68:71], v11, s[48:51], s57 offen offset:128
L_pdn_4:
    s_barrier
    s_branch L_FIN
L_UP:
    s_mov_b32 s58, 0xbfb8aa3b
    s_mov_b32 s63, 0xffff0000
    s_nop 3
    v_cndmask_b32 v64, v16, v20, s[66:67]
    v_cndmask_b32 v65, v17, v21, s[66:67]
    v_cndmask_b32 v66, v18, v22, s[66:67]
    v_cndmask_b32 v67, v19, v23, s[66:67]
    v_cndmask_b32 v68, v24, v28, s[66:67]
    v_cndmask_b32 v69, v25, v29, s[66:67]
    v_cndmask_b32 v70, v26, v30, s[66:67]
    v_cndmask_b32 v71, v27, v31, s[66:67]
    v_cvt_pk_bf16_f32 v56, v64, v65
    v_cvt_pk_bf16_f32 v57, v66, v67
    v_lshlrev_b32 v64, 16, v56
    v_and_b32 v65, s63, v56
    v_lshlrev_b32 v66, 16, v57
    v_and_b32 v67, s63, v57
    v_cvt_pk_bf16_f32 v56, v68, v69
    v_cvt_pk_bf16_f32 v57, v70, v71
    v_lshlrev_b32 v68, 16, v56
    v_and_b32 v69, s63, v56
    v_lshlrev_b32 v70, 16, v57
    v_and_b32 v71, s63, v57
    s_barrier
    s_mov_b32 s62, 524288
L_poll_5:
    buffer_load_dwordx4 v[48:51], v11, s[48:51], s57 offen offset:0 sc1 nt
    buffer_load_dwordx4 v[52:55], v11, s[48:51], s57 offen offset:128 sc1 nt
    s_waitcnt vmcnt(0)
    v_xor_b32 v2, v48, v60
    v_xor_b32 v3, v49, v61
    v_bitop3_b32 v2, v2, v50, v62 bitop3:0xf6
    v_bitop3_b32 v3, v3, v51, v63 bitop3:0xf6
    v_bitop3_b32 v2, v2, v52, v60 bitop3:0xf6
    v_bitop3_b32 v3, v3, v53, v61 bitop3:0xf6
    v_bitop3_b32 v2, v2, v54, v62 bitop3:0xf6
    v_bitop3_b32 v3, v3, v55, v63 bitop3:0xf6
    v_or_b32 v2, v2, v3
    v_and_b32 v2, 0xff, v2
    v_cmp_ne_u32 vcc, 0, v2
    s_cbranch_vccz L_pdone_6
    s_sleep 64
    s_sub_u32 s62, s62, 1
    s_cbranch_scc0 L_poll_5
L_pdone_6:
    s_mov_b64 exec, -1
    v_and_b32 v48, s59, v48
    v_and_b32 v49, s59, v49
    v_and_b32 v50, s59, v50
    v_and_b32 v51, s59, v51
    v_and_b32 v52, s59, v52
    v_and_b32 v53, s59, v53
    v_and_b32 v54, s59, v54
    v_and_b32 v55, s59, v55
    v_cvt_pk_bf16_f32 v56, v48, v49
    v_cvt_pk_bf16_f32 v57, v50, v51
    v_lshlrev_b32 v48, 16, v56
    v_and_b32 v49, s63, v56
    v_lshlrev_b32 v50, 16, v57
    v_and_b32 v51, s63, v57
    v_cvt_pk_bf16_f32 v56, v52, v53
    v_cvt_pk_bf16_f32 v57, v54, v55
    v_lshlrev_b32 v52, 16, v56
    v_and_b32 v53, s63, v56
    v_lshlrev_b32 v54, 16, v57
    v_and_b32 v55, s63, v57
    v_mul_f32 v16, s58, v48
    v_mul_f32 v17, s58, v49
    v_mul_f32 v18, s58, v50
    v_mul_f32 v19, s58, v51
    v_mul_f32 v20, s58, v52
    v_mul_f32 v21, s58, v53
    v_mul_f32 v22, s58, v54
    v_mul_f32 v23, s58, v55
    v_exp_f32 v16, v16
    v_exp_f32 v17, v17
    v_exp_f32 v18, v18
    v_exp_f32 v19, v19
    v_exp_f32 v20, v20
    v_exp_f32 v21, v21
    v_exp_f32 v22, v22
    v_exp_f32 v23, v23
    v_add_f32 v16, 1.0, v16
    v_add_f32 v17, 1.0, v17
    v_add_f32 v18, 1.0, v18
    v_add_f32 v19, 1.0, v19
    v_add_f32 v20, 1.0, v20
    v_add_f32 v21, 1.0, v21
    v_add_f32 v22, 1.0, v22
    v_add_f32 v23, 1.0, v23
    v_rcp_f32 v16, v16
    v_rcp_f32 v17, v17
    v_rcp_f32 v18, v18
    v_rcp_f32 v19, v19
    v_rcp_f32 v20, v20
    v_rcp_f32 v21, v21
    v_rcp_f32 v22, v22
    v_rcp_f32 v23, v23
    v_mul_f32 v48, v48, v16
    v_mul_f32 v49, v49, v17
    v_mul_f32 v50, v50, v18
    v_mul_f32 v51, v51, v19
    v_mul_f32 v52, v52, v20
    v_mul_f32 v53, v53, v21
    v_mul_f32 v54, v54, v22
    v_mul_f32 v55, v55, v23
    v_cvt_pk_bf16_f32 v56, v48, v49
    v_cvt_pk_bf16_f32 v57, v50, v51
    v_lshlrev_b32 v48, 16, v56
    v_and_b32 v49, s63, v56
    v_lshlrev_b32 v50, 16, v57
    v_and_b32 v51, s63, v57
    v_cvt_pk_bf16_f32 v56, v52, v53
    v_cvt_pk_bf16_f32 v57, v54, v55
    v_lshlrev_b32 v52, 16, v56
    v_and_b32 v53, s63, v56
    v_lshlrev_b32 v54, 16, v57
    v_and_b32 v55, s63, v57
    v_mul_f32 v64, v64, v48
    v_mul_f32 v65, v65, v49
    v_mul_f32 v66, v66, v50
    v_mul_f32 v67, v67, v51
    v_mul_f32 v68, v68, v52
    v_mul_f32 v69, v69, v53
    v_mul_f32 v70, v70, v54
    v_mul_f32 v71, v71, v55
    v_cvt_pk_bf16_f32 v56, v64, v65
    v_cvt_pk_bf16_f32 v57, v66, v67
    v_lshlrev_b32 v64, 16, v56
    v_and_b32 v65, s63, v56
    v_lshlrev_b32 v66, 16, v57
    v_and_b32 v67, s63, v57
    v_cvt_pk_bf16_f32 v56, v68, v69
    v_cvt_pk_bf16_f32 v57, v70, v71
    v_lshlrev_b32 v68, 16, v56
    v_and_b32 v69, s63, v56
    v_lshlrev_b32 v70, 16, v57
    v_and_b32 v71, s63, v57
    v_or_b32 v64, v64, v60
    v_or_b32 v65, v65, v61
    v_or_b32 v66, v66, v62
    v_or_b32 v67, v67, v63
    v_or_b32 v68, v68, v60
    v_or_b32 v69, v69, v61
    v_or_b32 v70, v70, v62
    v_or_b32 v71, v71, v63
    ds_read_b32 v3, v13
    s_add_u32 s57, s52, 458752
    s_waitcnt lgkmcnt(0)
    v_readfirstlane_b32 s64, v3
    s_cmp_eq_u32 s64, 1
    s_cbranch_scc1 L_ploc_7
    buffer_store_dwordx4 v[64:67], v11, s[48:51], s57 offen offset:0 sc1
    buffer_store_dwordx4 v[68:71], v11, s[48:51], s57 offen offset:128 sc1
    s_branch L_pdn_8
L_ploc_7:
    buffer_store_dwordx4 v[64:67], v11, s[48:51], s57 offen offset:0
    buffer_store_dwordx4 v[68:71], v11, s[48:51], s57 offen offset:128
L_pdn_8:
    s_cmp_ge_u32 s2, 144
    s_cbranch_scc1 L_end
    s_branch L_FIN
L_FFN2:
    v_lshrrev_b32 v6, 4, v0
    v_mul_u32_u24 v6, 4, v6
    v_bfe_u32 v10, v0, 2, 2
    v_add_u32 v6, v6, v10
    v_mul_u32_u24 v6, 128, v6
    v_and_b32 v10, 3, v0
    v_mul_u32_u24 v10, 16, v10
    v_add_u32 v6, v6, v10
    s_sub_u32 s53, s2, 184
    s_and_b32 s52, s53, 7
    s_lshr_b32 s53, s53, 3
    v_add_u32 v6, 36864, v6
    v_add_u32 v7, 36864, v6
    v_mul_u32_u24 v9, 18432, v5
    v_lshl_add_u32 v9, v8, 4, v9
    v_and_b32 v10, 8, v0
    v_lshl_add_u32 v9, v10, 3, v9
    s_mul_i32 s56, s52, 2304
    s_add_u32 s56, s56, 458752
    s_mov_b32 s58, 0x07060302
    v_mul_u32_u24 v11, 18432, v5
    v_add_u32 v11, v11, v12
    s_lshl_b32 s57, s53, 11
    s_lshl_b32 s63, s52, 7
    s_add_u32 s57, s57, s63
    s_add_u32 s57, s57, 655360
    s_barrier
    s_barrier
    s_mov_b32 s62, 524288
L_poll_9:
    buffer_load_dwordx4 v[72:75], v9, s[48:51], s56 offen offset:0 sc1 nt
    buffer_load_dwordx4 v[76:79], v9, s[48:51], s56 offen offset:128 sc1 nt
    buffer_load_dwordx4 v[80:83], v9, s[48:51], s56 offen offset:256 sc1 nt
    buffer_load_dwordx4 v[84:87], v9, s[48:51], s56 offen offset:384 sc1 nt
    buffer_load_dwordx4 v[88:91], v9, s[48:51], s56 offen offset:512 sc1 nt
    buffer_load_dwordx4 v[92:95], v9, s[48:51], s56 offen offset:640 sc1 nt
    buffer_load_dwordx4 v[96:99], v9, s[48:51], s56 offen offset:768 sc1 nt
    buffer_load_dwordx4 v[100:103], v9, s[48:51], s56 offen offset:896 sc1 nt
    buffer_load_dwordx4 v[104:107], v9, s[48:51], s56 offen offset:1024 sc1 nt
    buffer_load_dwordx4 v[108:111], v9, s[48:51], s56 offen offset:1152 sc1 nt
    buffer_load_dwordx4 v[112:115], v9, s[48:51], s56 offen offset:1280 sc1 nt
    buffer_load_dwordx4 v[116:119], v9, s[48:51], s56 offen offset:1408 sc1 nt
    buffer_load_dwordx4 v[120:123], v9, s[48:51], s56 offen offset:1536 sc1 nt
    buffer_load_dwordx4 v[124:127], v9, s[48:51], s56 offen offset:1664 sc1 nt
    buffer_load_dwordx4 v[128:131], v9, s[48:51], s56 offen offset:1792 sc1 nt
    buffer_load_dwordx4 v[132:135], v9, s[48:51], s56 offen offset:1920 sc1 nt
    buffer_load_dwordx4 v[136:139], v9, s[48:51], s56 offen offset:2048 sc1 nt
    buffer_load_dwordx4 v[140:143], v9, s[48:51], s56 offen offset:2176 sc1 nt
    s_waitcnt vmcnt(0)
    v_xor_b32 v2, v72, v60
    v_xor_b32 v3, v73, v61
    v_bitop3_b32 v2, v2, v74, v62 bitop3:0xf6
    v_bitop3_b32 v3, v3, v75, v63 bitop3:0xf6
    v_bitop3_b32 v2, v2, v76, v60 bitop3:0xf6
    v_bitop3_b32 v3, v3, v77, v61 bitop3:0xf6
    v_bitop3_b32 v2, v2, v78, v62 bitop3:0xf6
    v_bitop3_b32 v3, v3, v79, v63 bitop3:0xf6
    v_bitop3_b32 v2, v2, v80, v60 bitop3:0xf6
    v_bitop3_b32 v3, v3, v81, v61 bitop3:0xf6
    v_bitop3_b32 v2, v2, v82, v62 bitop3:0xf6
    v_bitop3_b32 v3, v3, v83, v63 bitop3:0xf6
    v_bitop3_b32 v2, v2, v84, v60 bitop3:0xf6
    v_bitop3_b32 v3, v3, v85, v61 bitop3:0xf6
    v_bitop3_b32 v2, v2, v86, v62 bitop3:0xf6
    v_bitop3_b32 v3, v3, v87, v63 bitop3:0xf6
    v_bitop3_b32 v2, v2, v88, v60 bitop3:0xf6
    v_bitop3_b32 v3, v3, v89, v61 bitop3:0xf6
    v_bitop3_b32 v2, v2, v90, v62 bitop3:0xf6
    v_bitop3_b32 v3, v3, v91, v63 bitop3:0xf6
    v_bitop3_b32 v2, v2, v92, v60 bitop3:0xf6
    v_bitop3_b32 v3, v3, v93, v61 bitop3:0xf6
    v_bitop3_b32 v2, v2, v94, v62 bitop3:0xf6
    v_bitop3_b32 v3, v3, v95, v63 bitop3:0xf6
    v_bitop3_b32 v2, v2, v96, v60 bitop3:0xf6
    v_bitop3_b32 v3, v3, v97, v61 bitop3:0xf6
    v_bitop3_b32 v2, v2, v98, v62 bitop3:0xf6
    v_bitop3_b32 v3, v3, v99, v63 bitop3:0xf6
    v_bitop3_b32 v2, v2, v100, v60 bitop3:0xf6
    v_bitop3_b32 v3, v3, v101, v61 bitop3:0xf6
    v_bitop3_b32 v2, v2, v102, v62 bitop3:0xf6
    v_bitop3_b32 v3, v3, v103, v63 bitop3:0xf6
    v_bitop3_b32 v2, v2, v104, v60 bitop3:0xf6
    v_bitop3_b32 v3, v3, v105, v61 bitop3:0xf6
    v_bitop3_b32 v2, v2, v106, v62 bitop3:0xf6
    v_bitop3_b32 v3, v3, v107, v63 bitop3:0xf6
    v_bitop3_b32 v2, v2, v108, v60 bitop3:0xf6
    v_bitop3_b32 v3, v3, v109, v61 bitop3:0xf6
    v_bitop3_b32 v2, v2, v110, v62 bitop3:0xf6
    v_bitop3_b32 v3, v3, v111, v63 bitop3:0xf6
    v_bitop3_b32 v2, v2, v112, v60 bitop3:0xf6
    v_bitop3_b32 v3, v3, v113, v61 bitop3:0xf6
    v_bitop3_b32 v2, v2, v114, v62 bitop3:0xf6
    v_bitop3_b32 v3, v3, v115, v63 bitop3:0xf6
    v_bitop3_b32 v2, v2, v116, v60 bitop3:0xf6
    v_bitop3_b32 v3, v3, v117, v61 bitop3:0xf6
    v_bitop3_b32 v2, v2, v118, v62 bitop3:0xf6
    v_bitop3_b32 v3, v3, v119, v63 bitop3:0xf6
    v_bitop3_b32 v2, v2, v120, v60 bitop3:0xf6
    v_bitop3_b32 v3, v3, v121, v61 bitop3:0xf6
    v_bitop3_b32 v2, v2, v122, v62 bitop3:0xf6
    v_bitop3_b32 v3, v3, v123, v63 bitop3:0xf6
    v_bitop3_b32 v2, v2, v124, v60 bitop3:0xf6
    v_bitop3_b32 v3, v3, v125, v61 bitop3:0xf6
    v_bitop3_b32 v2, v2, v126, v62 bitop3:0xf6
    v_bitop3_b32 v3, v3, v127, v63 bitop3:0xf6
    v_bitop3_b32 v2, v2, v128, v60 bitop3:0xf6
    v_bitop3_b32 v3, v3, v129, v61 bitop3:0xf6
    v_bitop3_b32 v2, v2, v130, v62 bitop3:0xf6
    v_bitop3_b32 v3, v3, v131, v63 bitop3:0xf6
    v_bitop3_b32 v2, v2, v132, v60 bitop3:0xf6
    v_bitop3_b32 v3, v3, v133, v61 bitop3:0xf6
    v_bitop3_b32 v2, v2, v134, v62 bitop3:0xf6
    v_bitop3_b32 v3, v3, v135, v63 bitop3:0xf6
    v_bitop3_b32 v2, v2, v136, v60 bitop3:0xf6
    v_bitop3_b32 v3, v3, v137, v61 bitop3:0xf6
    v_bitop3_b32 v2, v2, v138, v62 bitop3:0xf6
    v_bitop3_b32 v3, v3, v139, v63 bitop3:0xf6
    v_bitop3_b32 v2, v2, v140, v60 bitop3:0xf6
    v_bitop3_b32 v3, v3, v141, v61 bitop3:0xf6
    v_bitop3_b32 v2, v2, v142, v62 bitop3:0xf6
    v_bitop3_b32 v3, v3, v143, v63 bitop3:0xf6
    v_or_b32 v2, v2, v3
    v_and_b32 v2, 0xff, v2
    v_cmp_ne_u32 vcc, 0, v2
    s_cbranch_vccz L_pdone_10
    s_mov_b64 exec, vcc
    s_sleep 64
    s_sub_u32 s62, s62, 1
    s_cbranch_scc0 L_poll_9
L_pdone_10:
    s_mov_b64 exec, -1
    v_perm_b32 v72, v73, v72, s58
    v_perm_b32 v73, v75, v74, s58
    v_perm_b32 v76, v77, v76, s58
    v_perm_b32 v77, v79, v78, s58
    v_perm_b32 v80, v81, v80, s58
    v_perm_b32 v81, v83, v82, s58
    v_perm_b32 v84, v85, v84, s58
    v_perm_b32 v85, v87, v86, s58
    v_perm_b32 v88, v89, v88, s58
    v_perm_b32 v89, v91, v90, s58
    v_perm_b32 v92, v93, v92, s58
    v_perm_b32 v93, v95, v94, s58
    v_perm_b32 v96, v97, v96, s58
    v_perm_b32 v97, v99, v98, s58
    v_perm_b32 v100, v101, v100, s58
    v_perm_b32 v101, v103, v102, s58
    v_perm_b32 v104, v105, v104, s58
    v_perm_b32 v105, v107, v106, s58
    v_perm_b32 v108, v109, v108, s58
    v_perm_b32 v109, v111, v110, s58
    v_perm_b32 v112, v113, v112, s58
    v_perm_b32 v113, v115, v114, s58
    v_perm_b32 v116, v117, v116, s58
    v_perm_b32 v117, v119, v118, s58
    v_perm_b32 v120, v121, v120, s58
    v_perm_b32 v121, v123, v122, s58
    v_perm_b32 v124, v125, v124, s58
    v_perm_b32 v125, v127, v126, s58
    v_perm_b32 v128, v129, v128, s58
    v_perm_b32 v129, v131, v130, s58
    v_perm_b32 v132, v133, v132, s58
    v_perm_b32 v133, v135, v134, s58
    v_perm_b32 v136, v137, v136, s58
    v_perm_b32 v137, v139, v138, s58
    v_perm_b32 v140, v141, v140, s58
    v_perm_b32 v141, v143, v142, s58
    v_mov_b32_dpp v74, v72 row_ror:8 row_mask:0xf bank_mask:0xf
    v_mov_b32_dpp v75, v73 row_ror:8 row_mask:0xf bank_mask:0xf
    v_mov_b32_dpp v78, v76 row_ror:8 row_mask:0xf bank_mask:0xf
    v_mov_b32_dpp v79, v77 row_ror:8 row_mask:0xf bank_mask:0xf
    v_mov_b32_dpp v82, v80 row_ror:8 row_mask:0xf bank_mask:0xf
    v_mov_b32_dpp v83, v81 row_ror:8 row_mask:0xf bank_mask:0xf
    v_mov_b32_dpp v86, v84 row_ror:8 row_mask:0xf bank_mask:0xf
    v_mov_b32_dpp v87, v85 row_ror:8 row_mask:0xf bank_mask:0xf
    v_mov_b32_dpp v90, v88 row_ror:8 row_mask:0xf bank_mask:0xf
    v_mov_b32_dpp v91, v89 row_ror:8 row_mask:0xf bank_mask:0xf
    v_mov_b32_dpp v94, v92 row_ror:8 row_mask:0xf bank_mask:0xf
    v_mov_b32_dpp v95, v93 row_ror:8 row_mask:0xf bank_mask:0xf
    v_mov_b32_dpp v98, v96 row_ror:8 row_mask:0xf bank_mask:0xf
    v_mov_b32_dpp v99, v97 row_ror:8 row_mask:0xf bank_mask:0xf
    v_mov_b32_dpp v102, v100 row_ror:8 row_mask:0xf bank_mask:0xf
    v_mov_b32_dpp v103, v101 row_ror:8 row_mask:0xf bank_mask:0xf
    v_mov_b32_dpp v106, v104 row_ror:8 row_mask:0xf bank_mask:0xf
    v_mov_b32_dpp v107, v105 row_ror:8 row_mask:0xf bank_mask:0xf
    v_mov_b32_dpp v110, v108 row_ror:8 row_mask:0xf bank_mask:0xf
    v_mov_b32_dpp v111, v109 row_ror:8 row_mask:0xf bank_mask:0xf
    v_mov_b32_dpp v114, v112 row_ror:8 row_mask:0xf bank_mask:0xf
    v_mov_b32_dpp v115, v113 row_ror:8 row_mask:0xf bank_mask:0xf
    v_mov_b32_dpp v118, v116 row_ror:8 row_mask:0xf bank_mask:0xf
    v_mov_b32_dpp v119, v117 row_ror:8 row_mask:0xf bank_mask:0xf
    v_mov_b32_dpp v122, v120 row_ror:8 row_mask:0xf bank_mask:0xf
    v_mov_b32_dpp v123, v121 row_ror:8 row_mask:0xf bank_mask:0xf
    v_mov_b32_dpp v126, v124 row_ror:8 row_mask:0xf bank_mask:0xf
    v_mov_b32_dpp v127, v125 row_ror:8 row_mask:0xf bank_mask:0xf
    v_mov_b32_dpp v130, v128 row_ror:8 row_mask:0xf bank_mask:0xf
    v_mov_b32_dpp v131, v129 row_ror:8 row_mask:0xf bank_mask:0xf
    v_mov_b32_dpp v134, v132 row_ror:8 row_mask:0xf bank_mask:0xf
    v_mov_b32_dpp v135, v133 row_ror:8 row_mask:0xf bank_mask:0xf
    v_mov_b32_dpp v138, v136 row_ror:8 row_mask:0xf bank_mask:0xf
    v_mov_b32_dpp v139, v137 row_ror:8 row_mask:0xf bank_mask:0xf
    v_mov_b32_dpp v142, v140 row_ror:8 row_mask:0xf bank_mask:0xf
    v_mov_b32_dpp v143, v141 row_ror:8 row_mask:0xf bank_mask:0xf
    ds_read_b64_tr_b16 v[144:145], v6 offset:0
    ds_read_b64_tr_b16 v[146:147], v6 offset:2048
    ds_read_b64_tr_b16 v[148:149], v6 offset:8
    ds_read_b64_tr_b16 v[150:151], v6 offset:2056
    ds_read_b64_tr_b16 v[152:153], v6 offset:64
    ds_read_b64_tr_b16 v[154:155], v6 offset:2112
    ds_read_b64_tr_b16 v[156:157], v6 offset:72
    ds_read_b64_tr_b16 v[158:159], v6 offset:2120
    ds_read_b64_tr_b16 v[160:161], v6 offset:4096
    ds_read_b64_tr_b16 v[162:163], v6 offset:6144
    ds_read_b64_tr_b16 v[164:165], v6 offset:4104
    ds_read_b64_tr_b16 v[166:167], v6 offset:6152
    ds_read_b64_tr_b16 v[168:169], v6 offset:4160
    ds_read_b64_tr_b16 v[170:171], v6 offset:6208
    ds_read_b64_tr_b16 v[172:173], v6 offset:4168
    ds_read_b64_tr_b16 v[174:175], v6 offset:6216
    s_waitcnt lgkmcnt(8)
    v_mfma_f32_16x16x32_bf16 v[16:19], v[144:147], v[72:75], 0
    v_mfma_f32_16x16x32_bf16 v[20:23], v[148:151], v[72:75], 0
    v_mfma_f32_16x16x32_bf16 v[24:27], v[152:155], v[72:75], 0
    v_mfma_f32_16x16x32_bf16 v[28:31], v[156:159], v[72:75], 0
    ds_read_b64_tr_b16 v[144:145], v6 offset:8192
    ds_read_b64_tr_b16 v[146:147], v6 offset:10240
    ds_read_b64_tr_b16 v[148:149], v6 offset:8200
    ds_read_b64_tr_b16 v[150:151], v6 offset:10248
    ds_read_b64_tr_b16 v[152:153], v6 offset:8256
    ds_read_b64_tr_b16 v[154:155], v6 offset:10304
    ds_read_b64_tr_b16 v[156:157], v6 offset:8264
    ds_read_b64_tr_b16 v[158:159], v6 offset:10312
    s_waitcnt lgkmcnt(8)
    v_mfma_f32_16x16x32_bf16 v[16:19], v[160:163], v[76:79], v[16:19]
    v_mfma_f32_16x16x32_bf16 v[20:23], v[164:167], v[76:79], v[20:23]
    v_mfma_f32_16x16x32_bf16 v[24:27], v[168:171], v[76:79], v[24:27]
    v_mfma_f32_16x16x32_bf16 v[28:31], v[172:175], v[76:79], v[28:31]
    ds_read_b64_tr_b16 v[160:161], v6 offset:12288
    ds_read_b64_tr_b16 v[162:163], v6 offset:14336
    ds_read_b64_tr_b16 v[164:165], v6 offset:12296
    ds_read_b64_tr_b16 v[166:167], v6 offset:14344
    ds_read_b64_tr_b16 v[168:169], v6 offset:12352
    ds_read_b64_tr_b16 v[170:171], v6 offset:14400
    ds_read_b64_tr_b16 v[172:173], v6 offset:12360
    ds_read_b64_tr_b16 v[174:175], v6 offset:14408
    s_waitcnt lgkmcnt(8)
    v_mfma_f32_16x16x32_bf16 v[16:19], v[144:147], v[80:83], v[16:19]
    v_mfma_f32_16x16x32_bf16 v[20:23], v[148:151], v[80:83], v[20:23]
    v_mfma_f32_16x16x32_bf16 v[24:27], v[152:155], v[80:83], v[24:27]
    v_mfma_f32_16x16x32_bf16 v[28:31], v[156:159], v[80:83], v[28:31]
    ds_read_b64_tr_b16 v[144:145], v6 offset:16384
    ds_read_b64_tr_b16 v[146:147], v6 offset:18432
    ds_read_b64_tr_b16 v[148:149], v6 offset:16392
    ds_read_b64_tr_b16 v[150:151], v6 offset:18440
    ds_read_b64_tr_b16 v[152:153], v6 offset:16448
    ds_read_b64_tr_b16 v[154:155], v6 offset:18496
    ds_read_b64_tr_b16 v[156:157], v6 offset:16456
    ds_read_b64_tr_b16 v[158:159], v6 offset:18504
    s_waitcnt lgkmcnt(8)
    v_mfma_f32_16x16x32_bf16 v[16:19], v[160:163], v[84:87], v[16:19]
    v_mfma_f32_16x16x32_bf16 v[20:23], v[164:167], v[84:87], v[20:23]
    v_mfma_f32_16x16x32_bf16 v[24:27], v[168:171], v[84:87], v[24:27]
    v_mfma_f32_16x16x32_bf16 v[28:31], v[172:175], v[84:87], v[28:31]
    ds_read_b64_tr_b16 v[160:161], v6 offset:20480
    ds_read_b64_tr_b16 v[162:163], v6 offset:22528
    ds_read_b64_tr_b16 v[164:165], v6 offset:20488
    ds_read_b64_tr_b16 v[166:167], v6 offset:22536
    ds_read_b64_tr_b16 v[168:169], v6 offset:20544
    ds_read_b64_tr_b16 v[170:171], v6 offset:22592
    ds_read_b64_tr_b16 v[172:173], v6 offset:20552
    ds_read_b64_tr_b16 v[174:175], v6 offset:22600
    s_waitcnt lgkmcnt(8)
    v_mfma_f32_16x16x32_bf16 v[16:19], v[144:147], v[88:91], v[16:19]
    v_mfma_f32_16x16x32_bf16 v[20:23], v[148:151], v[88:91], v[20:23]
    v_mfma_f32_16x16x32_bf16 v[24:27], v[152:155], v[88:91], v[24:27]
    v_mfma_f32_16x16x32_bf16 v[28:31], v[156:159], v[88:91], v[28:31]
    ds_read_b64_tr_b16 v[144:145], v6 offset:24576
    ds_read_b64_tr_b16 v[146:147], v6 offset:26624
    ds_read_b64_tr_b16 v[148:149], v6 offset:24584
    ds_read_b64_tr_b16 v[150:151], v6 offset:26632
    ds_read_b64_tr_b16 v[152:153], v6 offset:24640
    ds_read_b64_tr_b16 v[154:155], v6 offset:26688
    ds_read_b64_tr_b16 v[156:157], v6 offset:24648
    ds_read_b64_tr_b16 v[158:159], v6 offset:26696
    s_waitcnt lgkmcnt(8)
    v_mfma_f32_16x16x32_bf16 v[16:19], v[160:163], v[92:95], v[16:19]
    v_mfma_f32_16x16x32_bf16 v[20:23], v[164:167], v[92:95], v[20:23]
    v_mfma_f32_16x16x32_bf16 v[24:27], v[168:171], v[92:95], v[24:27]
    v_mfma_f32_16x16x32_bf16 v[28:31], v[172:175], v[92:95], v[28:31]
    ds_read_b64_tr_b16 v[160:161], v6 offset:28672
    ds_read_b64_tr_b16 v[162:163], v6 offset:30720
    ds_read_b64_tr_b16 v[164:165], v6 offset:28680
    ds_read_b64_tr_b16 v[166:167], v6 offset:30728
    ds_read_b64_tr_b16 v[168:169], v6 offset:28736
    ds_read_b64_tr_b16 v[170:171], v6 offset:30784
    ds_read_b64_tr_b16 v[172:173], v6 offset:28744
    ds_read_b64_tr_b16 v[174:175], v6 offset:30792
    s_waitcnt lgkmcnt(8)
    v_mfma_f32_16x16x32_bf16 v[16:19], v[144:147], v[96:99], v[16:19]
    v_mfma_f32_16x16x32_bf16 v[20:23], v[148:151], v[96:99], v[20:23]
    v_mfma_f32_16x16x32_bf16 v[24:27], v[152:155], v[96:99], v[24:27]
    v_mfma_f32_16x16x32_bf16 v[28:31], v[156:159], v[96:99], v[28:31]
    ds_read_b64_tr_b16 v[144:145], v6 offset:32768
    ds_read_b64_tr_b16 v[146:147], v6 offset:34816
    ds_read_b64_tr_b16 v[148:149], v6 offset:32776
    ds_read_b64_tr_b16 v[150:151], v6 offset:34824
    ds_read_b64_tr_b16 v[152:153], v6 offset:32832
    ds_read_b64_tr_b16 v[154:155], v6 offset:34880
    ds_read_b64_tr_b16 v[156:157], v6 offset:32840
    ds_read_b64_tr_b16 v[158:159], v6 offset:34888
    s_waitcnt lgkmcnt(8)
    v_mfma_f32_16x16x32_bf16 v[16:19], v[160:163], v[100:103], v[16:19]
    v_mfma_f32_16x16x32_bf16 v[20:23], v[164:167], v[100:103], v[20:23]
    v_mfma_f32_16x16x32_bf16 v[24:27], v[168:171], v[100:103], v[24:27]
    v_mfma_f32_16x16x32_bf16 v[28:31], v[172:175], v[100:103], v[28:31]
    ds_read_b64_tr_b16 v[160:161], v7 offset:0
    ds_read_b64_tr_b16 v[162:163], v7 offset:2048
    ds_read_b64_tr_b16 v[164:165], v7 offset:8
    ds_read_b64_tr_b16 v[166:167], v7 offset:2056
    ds_read_b64_tr_b16 v[168:169], v7 offset:64
    ds_read_b64_tr_b16 v[170:171], v7 offset:2112
    ds_read_b64_tr_b16 v[172:173], v7 offset:72
    ds_read_b64_tr_b16 v[174:175], v7 offset:2120
    s_waitcnt lgkmcnt(8)
    v_mfma_f32_16x16x32_bf16 v[16:19], v[144:147], v[104:107], v[16:19]
    v_mfma_f32_16x16x32_bf16 v[20:23], v[148:151], v[104:107], v[20:23]
    v_mfma_f32_16x16x32_bf16 v[24:27], v[152:155], v[104:107], v[24:27]
    v_mfma_f32_16x16x32_bf16 v[28:31], v[156:159], v[104:107], v[28:31]
    ds_read_b64_tr_b16 v[144:145], v7 offset:4096
    ds_read_b64_tr_b16 v[146:147], v7 offset:6144
    ds_read_b64_tr_b16 v[148:149], v7 offset:4104
    ds_read_b64_tr_b16 v[150:151], v7 offset:6152
    ds_read_b64_tr_b16 v[152:153], v7 offset:4160
    ds_read_b64_tr_b16 v[154:155], v7 offset:6208
    ds_read_b64_tr_b16 v[156:157], v7 offset:4168
    ds_read_b64_tr_b16 v[158:159], v7 offset:6216
    s_waitcnt lgkmcnt(8)
    v_mfma_f32_16x16x32_bf16 v[16:19], v[160:163], v[108:111], v[16:19]
    v_mfma_f32_16x16x32_bf16 v[20:23], v[164:167], v[108:111], v[20:23]
    v_mfma_f32_16x16x32_bf16 v[24:27], v[168:171], v[108:111], v[24:27]
    v_mfma_f32_16x16x32_bf16 v[28:31], v[172:175], v[108:111], v[28:31]
    ds_read_b64_tr_b16 v[160:161], v7 offset:8192
    ds_read_b64_tr_b16 v[162:163], v7 offset:10240
    ds_read_b64_tr_b16 v[164:165], v7 offset:8200
    ds_read_b64_tr_b16 v[166:167], v7 offset:10248
    ds_read_b64_tr_b16 v[168:169], v7 offset:8256
    ds_read_b64_tr_b16 v[170:171], v7 offset:10304
    ds_read_b64_tr_b16 v[172:173], v7 offset:8264
    ds_read_b64_tr_b16 v[174:175], v7 offset:10312
    s_waitcnt lgkmcnt(8)
    v_mfma_f32_16x16x32_bf16 v[16:19], v[144:147], v[112:115], v[16:19]
    v_mfma_f32_16x16x32_bf16 v[20:23], v[148:151], v[112:115], v[20:23]
    v_mfma_f32_16x16x32_bf16 v[24:27], v[152:155], v[112:115], v[24:27]
    v_mfma_f32_16x16x32_bf16 v[28:31], v[156:159], v[112:115], v[28:31]
    ds_read_b64_tr_b16 v[144:145], v7 offset:12288
    ds_read_b64_tr_b16 v[146:147], v7 offset:14336
    ds_read_b64_tr_b16 v[148:149], v7 offset:12296
    ds_read_b64_tr_b16 v[150:151], v7 offset:14344
    ds_read_b64_tr_b16 v[152:153], v7 offset:12352
    ds_read_b64_tr_b16 v[154:155], v7 offset:14400
    ds_read_b64_tr_b16 v[156:157], v7 offset:12360
    ds_read_b64_tr_b16 v[158:159], v7 offset:14408
    s_waitcnt lgkmcnt(8)
    v_mfma_f32_16x16x32_bf16 v[16:19], v[160:163], v[116:119], v[16:19]
    v_mfma_f32_16x16x32_bf16 v[20:23], v[164:167], v[116:119], v[20:23]
    v_mfma_f32_16x16x32_bf16 v[24:27], v[168:171], v[116:119], v[24:27]
    v_mfma_f32_16x16x32_bf16 v[28:31], v[172:175], v[116:119], v[28:31]
    ds_read_b64_tr_b16 v[160:161], v7 offset:16384
    ds_read_b64_tr_b16 v[162:163], v7 offset:18432
    ds_read_b64_tr_b16 v[164:165], v7 offset:16392
    ds_read_b64_tr_b16 v[166:167], v7 offset:18440
    ds_read_b64_tr_b16 v[168:169], v7 offset:16448
    ds_read_b64_tr_b16 v[170:171], v7 offset:18496
    ds_read_b64_tr_b16 v[172:173], v7 offset:16456
    ds_read_b64_tr_b16 v[174:175], v7 offset:18504
    s_waitcnt lgkmcnt(8)
    v_mfma_f32_16x16x32_bf16 v[16:19], v[144:147], v[120:123], v[16:19]
    v_mfma_f32_16x16x32_bf16 v[20:23], v[148:151], v[120:123], v[20:23]
    v_mfma_f32_16x16x32_bf16 v[24:27], v[152:155], v[120:123], v[24:27]
    v_mfma_f32_16x16x32_bf16 v[28:31], v[156:159], v[120:123], v[28:31]
    ds_read_b64_tr_b16 v[144:145], v7 offset:20480
    ds_read_b64_tr_b16 v[146:147], v7 offset:22528
    ds_read_b64_tr_b16 v[148:149], v7 offset:20488
    ds_read_b64_tr_b16 v[150:151], v7 offset:22536
    ds_read_b64_tr_b16 v[152:153], v7 offset:20544
    ds_read_b64_tr_b16 v[154:155], v7 offset:22592
    ds_read_b64_tr_b16 v[156:157], v7 offset:20552
    ds_read_b64_tr_b16 v[158:159], v7 offset:22600
    s_waitcnt lgkmcnt(8)
    v_mfma_f32_16x16x32_bf16 v[16:19], v[160:163], v[124:127], v[16:19]
    v_mfma_f32_16x16x32_bf16 v[20:23], v[164:167], v[124:127], v[20:23]
    v_mfma_f32_16x16x32_bf16 v[24:27], v[168:171], v[124:127], v[24:27]
    v_mfma_f32_16x16x32_bf16 v[28:31], v[172:175], v[124:127], v[28:31]
    ds_read_b64_tr_b16 v[160:161], v7 offset:24576
    ds_read_b64_tr_b16 v[162:163], v7 offset:26624
    ds_read_b64_tr_b16 v[164:165], v7 offset:24584
    ds_read_b64_tr_b16 v[166:167], v7 offset:26632
    ds_read_b64_tr_b16 v[168:169], v7 offset:24640
    ds_read_b64_tr_b16 v[170:171], v7 offset:26688
    ds_read_b64_tr_b16 v[172:173], v7 offset:24648
    ds_read_b64_tr_b16 v[174:175], v7 offset:26696
    s_waitcnt lgkmcnt(8)
    v_mfma_f32_16x16x32_bf16 v[16:19], v[144:147], v[128:131], v[16:19]
    v_mfma_f32_16x16x32_bf16 v[20:23], v[148:151], v[128:131], v[20:23]
    v_mfma_f32_16x16x32_bf16 v[24:27], v[152:155], v[128:131], v[24:27]
    v_mfma_f32_16x16x32_bf16 v[28:31], v[156:159], v[128:131], v[28:31]
    ds_read_b64_tr_b16 v[144:145], v7 offset:28672
    ds_read_b64_tr_b16 v[146:147], v7 offset:30720
    ds_read_b64_tr_b16 v[148:149], v7 offset:28680
    ds_read_b64_tr_b16 v[150:151], v7 offset:30728
    ds_read_b64_tr_b16 v[152:153], v7 offset:28736
    ds_read_b64_tr_b16 v[154:155], v7 offset:30784
    ds_read_b64_tr_b16 v[156:157], v7 offset:28744
    ds_read_b64_tr_b16 v[158:159], v7 offset:30792
    s_waitcnt lgkmcnt(8)
    v_mfma_f32_16x16x32_bf16 v[16:19], v[160:163], v[132:135], v[16:19]
    v_mfma_f32_16x16x32_bf16 v[20:23], v[164:167], v[132:135], v[20:23]
    v_mfma_f32_16x16x32_bf16 v[24:27], v[168:171], v[132:135], v[24:27]
    v_mfma_f32_16x16x32_bf16 v[28:31], v[172:175], v[132:135], v[28:31]
    ds_read_b64_tr_b16 v[160:161], v7 offset:32768
    ds_read_b64_tr_b16 v[162:163], v7 offset:34816
    ds_read_b64_tr_b16 v[164:165], v7 offset:32776
    ds_read_b64_tr_b16 v[166:167], v7 offset:34824
    ds_read_b64_tr_b16 v[168:169], v7 offset:32832
    ds_read_b64_tr_b16 v[170:171], v7 offset:34880
    ds_read_b64_tr_b16 v[172:173], v7 offset:32840
    ds_read_b64_tr_b16 v[174:175], v7 offset:34888
    s_waitcnt lgkmcnt(8)
    v_mfma_f32_16x16x32_bf16 v[16:19], v[144:147], v[136:139], v[16:19]
    v_mfma_f32_16x16x32_bf16 v[20:23], v[148:151], v[136:139], v[20:23]
    v_mfma_f32_16x16x32_bf16 v[24:27], v[152:155], v[136:139], v[24:27]
    v_mfma_f32_16x16x32_bf16 v[28:31], v[156:159], v[136:139], v[28:31]
    s_waitcnt lgkmcnt(0)
    v_mfma_f32_16x16x32_bf16 v[16:19], v[160:163], v[140:143], v[16:19]
    v_mfma_f32_16x16x32_bf16 v[20:23], v[164:167], v[140:143], v[20:23]
    v_mfma_f32_16x16x32_bf16 v[24:27], v[168:171], v[140:143], v[24:27]
    v_mfma_f32_16x16x32_bf16 v[28:31], v[172:175], v[140:143], v[28:31]
    s_nop 7
    v_mov_b32_dpp v16, v20 row_ror:8 row_mask:0xf bank_mask:0xc
    v_mov_b32_dpp v17, v21 row_ror:8 row_mask:0xf bank_mask:0xc
    v_mov_b32_dpp v18, v22 row_ror:8 row_mask:0xf bank_mask:0xc
    v_mov_b32_dpp v19, v23 row_ror:8 row_mask:0xf bank_mask:0xc
    v_mov_b32_dpp v24, v28 row_ror:8 row_mask:0xf bank_mask:0xc
    v_mov_b32_dpp v25, v29 row_ror:8 row_mask:0xf bank_mask:0xc
    v_mov_b32_dpp v26, v30 row_ror:8 row_mask:0xf bank_mask:0xc
    v_mov_b32_dpp v27, v31 row_ror:8 row_mask:0xf bank_mask:0xc
    v_bfi_b32 v64, s59, v16, v60
    v_bfi_b32 v65, s59, v17, v61
    v_bfi_b32 v66, s59, v18, v62
    v_bfi_b32 v67, s59, v19, v63
    v_bfi_b32 v68, s59, v24, v60
    v_bfi_b32 v69, s59, v25, v61
    v_bfi_b32 v70, s59, v26, v62
    v_bfi_b32 v71, s59, v27, v63
    buffer_store_dwordx4 v[64:67], v11, s[48:51], s57 offen offset:0 sc1
    buffer_store_dwordx4 v[68:71], v11, s[48:51], s57 offen offset:1024 sc1
    s_endpgm
L_HB2:
    s_setprio 0
    s_getreg_b32 s65, hwreg(HW_REG_XCC_ID)
    s_and_b32 s65, s65, 15
    s_add_u32 s65, s65, s89
    s_and_b32 s64, s2, 7
    s_mul_i32 s64, s64, 1280
    s_add_u32 s64, s64, 45056
    v_and_b32 v15, 31, v0
    v_lshlrev_b32 v15, 2, v15
    buffer_load_dword v14, v15, s[48:51], s64 offen sc1
    s_waitcnt vmcnt(0)
    v_cmp_ne_u32 vcc, s65, v14
    s_nop 0
    s_cmp_eq_u64 vcc, 0
    s_cselect_b32 s64, 1, 0
    v_mov_b32 v2, 143624
    v_mov_b32 v3, s64
    ds_write_b32 v2, v3
    s_cmp_ge_u32 s2, 32
    s_cbranch_scc1 L_nozero
    s_mul_i32 s40, s2, 1280
    s_add_u32 s40, s40, 4096
    v_mov_b32 v2, 0
    s_mov_b64 exec, 1
    buffer_store_dword v2, v2, s[48:51], s40 offen sc1
    s_mov_b64 exec, -1
L_nozero:
    v_lshrrev_b32 v8, 4, v0
    v_and_b32 v11, 8, v0
    v_lshlrev_b32 v11, 3, v11
    v_lshl_add_u32 v11, v8, 4, v11
    v_and_b32 v10, 7, v0
    v_lshl_add_u32 v12, v10, 9, v11
    v_mul_u32_u24 v14, 36864, v10
    v_add_u32 v14, v14, v11
    s_and_b32 s68, s2, 7
    s_bfe_u32 s69, s2, 0x10003
    s_lshl_b32 s69, s69, 4
    s_add_u32 s68, s68, s69
    s_lshl_b32 s72, s68, 12
    s_add_u32 s72, s72, 1048576
    s_add_u32 s73, s72, 32768
    s_lshr_b32 s74, s2, 4
    s_lshl_b32 s74, s74, 12
    s_and_b32 s75, s2, 15
    s_mul_i32 s75, s75, 128
    s_add_u32 s74, s74, s75
    s_add_u32 s74, s74, 1310720
    s_mov_b32 s71, 0x07060302
    s_cmp_ge_u32 s2, 144
    s_cbranch_scc1 L_HB3
    s_cmp_lt_u32 s2, 40
    s_cselect_b32 s65, 36864, 0
    v_lshrrev_b32 v6, 4, v0
    v_mul_u32_u24 v6, 4, v6
    v_bfe_u32 v7, v0, 2, 2
    v_add_u32 v6, v6, v7
    v_mul_u32_u24 v6, 128, v6
    v_and_b32 v7, 3, v0
    v_mul_u32_u24 v7, 8, v7
    v_add_u32 v6, v6, v7
    v_add_u32 v6, s65, v6
    ds_read_b64_tr_b16 v[64:65], v6 offset:0
    ds_read_b64_tr_b16 v[66:67], v6 offset:2048
    ds_read_b64_tr_b16 v[68:69], v6 offset:4096
    ds_read_b64_tr_b16 v[70:71], v6 offset:6144
    ds_read_b64_tr_b16 v[72:73], v6 offset:8192
    ds_read_b64_tr_b16 v[74:75], v6 offset:10240
    ds_read_b64_tr_b16 v[76:77], v6 offset:12288
    ds_read_b64_tr_b16 v[78:79], v6 offset:14336
    s_waitcnt lgkmcnt(0)
    ds_read_b64_tr_b16 v[80:81], v6 offset:16384
    ds_read_b64_tr_b16 v[82:83], v6 offset:18432
    ds_read_b64_tr_b16 v[84:85], v6 offset:20480
    ds_read_b64_tr_b16 v[86:87], v6 offset:22528
    ds_read_b64_tr_b16 v[88:89], v6 offset:24576
    ds_read_b64_tr_b16 v[90:91], v6 offset:26624
    ds_read_b64_tr_b16 v[92:93], v6 offset:28672
    ds_read_b64_tr_b16 v[94:95], v6 offset:30720
    s_waitcnt lgkmcnt(0)
    ds_read_b64_tr_b16 v[96:97], v6 offset:32
    ds_read_b64_tr_b16 v[98:99], v6 offset:2080
    ds_read_b64_tr_b16 v[100:101], v6 offset:4128
    ds_read_b64_tr_b16 v[102:103], v6 offset:6176
    ds_read_b64_tr_b16 v[104:105], v6 offset:8224
    ds_read_b64_tr_b16 v[106:107], v6 offset:10272
    ds_read_b64_tr_b16 v[108:109], v6 offset:12320
    ds_read_b64_tr_b16 v[110:111], v6 offset:14368
    s_waitcnt lgkmcnt(0)
    ds_read_b64_tr_b16 v[112:113], v6 offset:16416
    ds_read_b64_tr_b16 v[114:115], v6 offset:18464
    ds_read_b64_tr_b16 v[116:117], v6 offset:20512
    ds_read_b64_tr_b16 v[118:119], v6 offset:22560
    ds_read_b64_tr_b16 v[120:121], v6 offset:24608
    ds_read_b64_tr_b16 v[122:123], v6 offset:26656
    ds_read_b64_tr_b16 v[124:125], v6 offset:28704
    ds_read_b64_tr_b16 v[126:127], v6 offset:30752
    s_waitcnt lgkmcnt(0)
    ds_read_b64_tr_b16 v[128:129], v6 offset:64
    ds_read_b64_tr_b16 v[130:131], v6 offset:2112
    ds_read_b64_tr_b16 v[132:133], v6 offset:4160
    ds_read_b64_tr_b16 v[134:135], v6 offset:6208
    ds_read_b64_tr_b16 v[136:137], v6 offset:8256
    ds_read_b64_tr_b16 v[138:139], v6 offset:10304
    ds_read_b64_tr_b16 v[140:141], v6 offset:12352
    ds_read_b64_tr_b16 v[142:143], v6 offset:14400
    s_waitcnt lgkmcnt(0)
    ds_read_b64_tr_b16 v[144:145], v6 offset:16448
    ds_read_b64_tr_b16 v[146:147], v6 offset:18496
    ds_read_b64_tr_b16 v[148:149], v6 offset:20544
    ds_read_b64_tr_b16 v[150:151], v6 offset:22592
    ds_read_b64_tr_b16 v[152:153], v6 offset:24640
    ds_read_b64_tr_b16 v[154:155], v6 offset:26688
    ds_read_b64_tr_b16 v[156:157], v6 offset:28736
    ds_read_b64_tr_b16 v[158:159], v6 offset:30784
    s_waitcnt lgkmcnt(0)
    ds_read_b64_tr_b16 v[160:161], v6 offset:96
    ds_read_b64_tr_b16 v[162:163], v6 offset:2144
    ds_read_b64_tr_b16 v[164:165], v6 offset:4192
    ds_read_b64_tr_b16 v[166:167], v6 offset:6240
    ds_read_b64_tr_b16 v[168:169], v6 offset:8288
    ds_read_b64_tr_b16 v[170:171], v6 offset:10336
    ds_read_b64_tr_b16 v[172:173], v6 offset:12384
    ds_read_b64_tr_b16 v[174:175], v6 offset:14432
    s_waitcnt lgkmcnt(0)
    ds_read_b64_tr_b16 v[176:177], v6 offset:16480
    ds_read_b64_tr_b16 v[178:179], v6 offset:18528
    ds_read_b64_tr_b16 v[180:181], v6 offset:20576
    ds_read_b64_tr_b16 v[182:183], v6 offset:22624
    ds_read_b64_tr_b16 v[184:185], v6 offset:24672
    ds_read_b64_tr_b16 v[186:187], v6 offset:26720
    ds_read_b64_tr_b16 v[188:189], v6 offset:28768
    ds_read_b64_tr_b16 v[190:191], v6 offset:30816
    s_waitcnt lgkmcnt(0)
L_HB3:
    s_barrier
    s_barrier
    s_bfe_u32 s40, s2, 0x20003
    s_mul_i32 s40, s40, 1280
    s_add_u32 s40, s40, 4096
    s_add_u32 s42, s28, s40
    s_addc_u32 s43, s29, 0
    s_mov_b32 s40, 1
    s_atomic_add s40, s[42:43], 0 glc
    s_waitcnt lgkmcnt(0)
    s_min_u32 s40, s40, 63
    s_mov_b32 s41, 0x41480000
    s_mov_b32 s42, 0x41200000
    v_cvt_f32_u32 v2, s40
    v_mul_f32 v2, 0x3d000000, v2
    v_add_f32 v2, 0xbf7c0000, v2
    v_mul_f32 v3, v2, v2
    v_mul_f32 v4, v3, v3
    v_mul_f32 v4, v4, v4
    v_mul_f32 v4, 0x3f400000, v4
    v_fmac_f32 v4, 0.5, v3
    v_add_f32 v4, 0x3f99999a, v4
    v_mul_f32 v2, v2, v4
    s_cmp_ge_u32 s40, 32
    s_cselect_b32 s41, s41, s42
    s_cselect_b32 s43, 1, 2
    v_fma_f32 v2, abs(v2), s41, 0.5
    v_cvt_u32_f32 v2, v2
    s_nop 0
    v_readfirstlane_b32 s44, v2
    s_sub_u32 s45, 60, s44
    s_max_i32 s45, s45, 0
    s_lshl_b32 s45, s45, 2
    s_or_b32 s45, s45, s43
    s_cmp_eq_u32 s44, 0
    s_cselect_b32 s45, 0, s45
    v_mov_b32 v2, 143616
    v_mov_b32 v3, s45
    ds_write_b32 v2, v3
L_nock_13:
    s_barrier
    s_bfe_u32 s40, s2, 0x20003
    s_mul_i32 s40, s40, 1280
    s_add_u32 s40, s40, 14336
    s_add_u32 s42, s28, s40
    s_addc_u32 s43, s29, 0
    s_mov_b32 s40, 1
    s_atomic_add s40, s[42:43], 0 glc
    s_waitcnt lgkmcnt(0)
    s_min_u32 s40, s40, 63
    s_mov_b32 s41, 0x40d00000
    s_mov_b32 s42, 0x40b00000
    v_cvt_f32_u32 v2, s40
    v_mul_f32 v2, 0x3d000000, v2
    v_add_f32 v2, 0xbf7c0000, v2
    v_mul_f32 v3, v2, v2
    v_mul_f32 v4, v3, v3
    v_mul_f32 v4, v4, v4
    v_mul_f32 v4, 0x3f400000, v4
    v_fmac_f32 v4, 0.5, v3
    v_add_f32 v4, 0x3f99999a, v4
    v_mul_f32 v2, v2, v4
    s_cmp_ge_u32 s40, 32
    s_cselect_b32 s41, s41, s42
    s_cselect_b32 s43, 1, 2
    v_fma_f32 v2, abs(v2), s41, 0.5
    v_cvt_u32_f32 v2, v2
    s_nop 0
    v_readfirstlane_b32 s44, v2
    s_sub_u32 s45, 33, s44
    s_max_i32 s45, s45, 0
    s_lshl_b32 s45, s45, 2
    s_or_b32 s45, s45, s43
    s_cmp_eq_u32 s44, 0
    s_cselect_b32 s45, 0, s45
    v_mov_b32 v2, 143616
    v_mov_b32 v3, s45
    ds_write_b32 v2, v3
L_nock_14:
    s_barrier
    s_bfe_u32 s40, s2, 0x20003
    s_mul_i32 s40, s40, 1280
    s_add_u32 s40, s40, 24576
    s_add_u32 s42, s28, s40
    s_addc_u32 s43, s29, 0
    s_mov_b32 s40, 1
    s_atomic_add s40, s[42:43], 0 glc
    s_waitcnt lgkmcnt(0)
    s_min_u32 s40, s40, 63
    s_mov_b32 s41, 0x40b00000
    s_mov_b32 s42, 0x40900000
    v_cvt_f32_u32 v2, s40
    v_mul_f32 v2, 0x3d000000, v2
    v_add_f32 v2, 0xbf7c0000, v2
    v_mul_f32 v3, v2, v2
    v_mul_f32 v4, v3, v3
    v_mul_f32 v4, v4, v4
    v_mul_f32 v4, 0x3f400000, v4
    v_fmac_f32 v4, 0.5, v3
    v_add_f32 v4, 0x3f99999a, v4
    v_mul_f32 v2, v2, v4
    s_cmp_ge_u32 s40, 32
    s_cselect_b32 s41, s41, s42
    s_cselect_b32 s43, 1, 2
    v_fma_f32 v2, abs(v2), s41, 0.5
    v_cvt_u32_f32 v2, v2
    s_nop 0
    v_readfirstlane_b32 s44, v2
    s_sub_u32 s45, 16, s44
    s_max_i32 s45, s45, 0
    s_lshl_b32 s45, s45, 2
    s_or_b32 s45, s45, s43
    s_cmp_eq_u32 s44, 0
    s_cselect_b32 s45, 0, s45
    v_mov_b32 v2, 143616
    v_mov_b32 v3, s45
    ds_write_b32 v2, v3
L_nock_15:
    s_barrier
    s_bfe_u32 s40, s2, 0x20003
    s_mul_i32 s40, s40, 1280
    s_add_u32 s40, s40, 34816
    s_add_u32 s42, s28, s40
    s_addc_u32 s43, s29, 0
    s_mov_b32 s40, 1
    s_atomic_add s40, s[42:43], 0 glc
    s_waitcnt lgkmcnt(0)
    s_min_u32 s40, s40, 63
    s_mov_b32 s41, 0x40866666
    s_mov_b32 s42, 0x40333333
    v_cvt_f32_u32 v2, s40
    v_mul_f32 v2, 0x3d000000, v2
    v_add_f32 v2, 0xbf7c0000, v2
    v_mul_f32 v3, v2, v2
    v_mul_f32 v4, v3, v3
    v_mul_f32 v4, v4, v4
    v_mul_f32 v4, 0x3f400000, v4
    v_fmac_f32 v4, 0.5, v3
    v_add_f32 v4, 0x3f99999a, v4
    v_mul_f32 v2, v2, v4
    s_cmp_ge_u32 s40, 32
    s_cselect_b32 s41, s41, s42
    s_cselect_b32 s43, 1, 2
    v_fma_f32 v2, abs(v2), s41, 0.5
    v_cvt_u32_f32 v2, v2
    s_nop 0
    v_readfirstlane_b32 s44, v2
    s_sub_u32 s45, 5, s44
    s_max_i32 s45, s45, 0
    s_lshl_b32 s45, s45, 2
    s_or_b32 s45, s45, s43
    s_cmp_eq_u32 s44, 0
    s_cselect_b32 s45, 0, s45
    v_mov_b32 v2, 143616
    v_mov_b32 v3, s45
    ds_write_b32 v2, v3
L_nock_16:
    s_cmp_ge_u32 s2, 144
    s_cbranch_scc1 L_hbend
    s_setprio 3
    s_barrier
    s_mov_b32 s62, 4194304
L_poll_17:
    buffer_load_dwordx4 v[192:195], v12, s[48:51], s72 offen offset:0 sc1 nt
    buffer_load_dwordx4 v[196:199], v12, s[48:51], s72 offen offset:128 sc1 nt
    buffer_load_dwordx4 v[200:203], v12, s[48:51], s72 offen offset:256 sc1 nt
    buffer_load_dwordx4 v[204:207], v12, s[48:51], s72 offen offset:384 sc1 nt
    buffer_load_dwordx4 v[208:211], v12, s[48:51], s73 offen offset:0 sc1 nt
    buffer_load_dwordx4 v[212:215], v12, s[48:51], s73 offen offset:128 sc1 nt
    buffer_load_dwordx4 v[216:219], v12, s[48:51], s73 offen offset:256 sc1 nt
    buffer_load_dwordx4 v[220:223], v12, s[48:51], s73 offen offset:384 sc1 nt
    s_waitcnt vmcnt(0)
    v_xor_b32 v2, v192, v60
    v_xor_b32 v3, v193, v61
    v_bitop3_b32 v2, v2, v194, v62 bitop3:0xf6
    v_bitop3_b32 v3, v3, v195, v63 bitop3:0xf6
    v_bitop3_b32 v2, v2, v196, v60 bitop3:0xf6
    v_bitop3_b32 v3, v3, v197, v61 bitop3:0xf6
    v_bitop3_b32 v2, v2, v198, v62 bitop3:0xf6
    v_bitop3_b32 v3, v3, v199, v63 bitop3:0xf6
    v_bitop3_b32 v2, v2, v200, v60 bitop3:0xf6
    v_bitop3_b32 v3, v3, v201, v61 bitop3:0xf6
    v_bitop3_b32 v2, v2, v202, v62 bitop3:0xf6
    v_bitop3_b32 v3, v3, v203, v63 bitop3:0xf6
    v_bitop3_b32 v2, v2, v204, v60 bitop3:0xf6
    v_bitop3_b32 v3, v3, v205, v61 bitop3:0xf6
    v_bitop3_b32 v2, v2, v206, v62 bitop3:0xf6
    v_bitop3_b32 v3, v3, v207, v63 bitop3:0xf6
    v_bitop3_b32 v2, v2, v208, v60 bitop3:0xf6
    v_bitop3_b32 v3, v3, v209, v61 bitop3:0xf6
    v_bitop3_b32 v2, v2, v210, v62 bitop3:0xf6
    v_bitop3_b32 v3, v3, v211, v63 bitop3:0xf6
    v_bitop3_b32 v2, v2, v212, v60 bitop3:0xf6
    v_bitop3_b32 v3, v3, v213, v61 bitop3:0xf6
    v_bitop3_b32 v2, v2, v214, v62 bitop3:0xf6
    v_bitop3_b32 v3, v3, v215, v63 bitop3:0xf6
    v_bitop3_b32 v2, v2, v216, v60 bitop3:0xf6
    v_bitop3_b32 v3, v3, v217, v61 bitop3:0xf6
    v_bitop3_b32 v2, v2, v218, v62 bitop3:0xf6
    v_bitop3_b32 v3, v3, v219, v63 bitop3:0xf6
    v_bitop3_b32 v2, v2, v220, v60 bitop3:0xf6
    v_bitop3_b32 v3, v3, v221, v61 bitop3:0xf6
    v_bitop3_b32 v2, v2, v222, v62 bitop3:0xf6
    v_bitop3_b32 v3, v3, v223, v63 bitop3:0xf6
    v_or_b32 v2, v2, v3
    v_and_b32 v2, 0xff, v2
    v_cmp_ne_u32 vcc, 0, v2
    s_cbranch_vccz L_pdone_18
    s_mov_b64 exec, vcc
    s_sub_u32 s62, s62, 1
    s_cbranch_scc0 L_poll_17
L_pdone_18:
    s_mov_b64 exec, -1
    s_barrier
    v_perm_b32 v192, v193, v192, s71
    v_perm_b32 v193, v195, v194, s71
    v_perm_b32 v196, v197, v196, s71
    v_perm_b32 v197, v199, v198, s71
    v_mov_b32_dpp v194, v192 row_ror:8 row_mask:0xf bank_mask:0xf
    v_mov_b32_dpp v195, v193 row_ror:8 row_mask:0xf bank_mask:0xf
    v_mov_b32_dpp v198, v196 row_ror:8 row_mask:0xf bank_mask:0xf
    v_mov_b32_dpp v199, v197 row_ror:8 row_mask:0xf bank_mask:0xf
    v_mfma_f32_16x16x32_bf16 v[44:47], v[64:67], v[192:195], 0
    v_perm_b32 v200, v201, v200, s71
    v_perm_b32 v201, v203, v202, s71
    v_mfma_f32_16x16x32_bf16 v[48:51], v[96:99], v[192:195], 0
    v_mfma_f32_16x16x32_bf16 v[52:55], v[128:131], v[192:195], 0
    v_mov_b32_dpp v202, v200 row_ror:8 row_mask:0xf bank_mask:0xf
    v_mov_b32_dpp v203, v201 row_ror:8 row_mask:0xf bank_mask:0xf
    v_mfma_f32_16x16x32_bf16 v[56:59], v[160:163], v[192:195], 0
    v_mfma_f32_16x16x32_bf16 v[44:47], v[68:71], v[196:199], v[44:47]
    v_perm_b32 v204, v205, v204, s71
    v_perm_b32 v205, v207, v206, s71
    v_mfma_f32_16x16x32_bf16 v[48:51], v[100:103], v[196:199], v[48:51]
    v_mfma_f32_16x16x32_bf16 v[52:55], v[132:135], v[196:199], v[52:55]
    v_mov_b32_dpp v206, v204 row_ror:8 row_mask:0xf bank_mask:0xf
    v_mov_b32_dpp v207, v205 row_ror:8 row_mask:0xf bank_mask:0xf
    v_mfma_f32_16x16x32_bf16 v[56:59], v[164:167], v[196:199], v[56:59]
    v_mfma_f32_16x16x32_bf16 v[44:47], v[72:75], v[200:203], v[44:47]
    v_perm_b32 v208, v209, v208, s71
    v_perm_b32 v209, v211, v210, s71
    v_mfma_f32_16x16x32_bf16 v[48:51], v[104:107], v[200:203], v[48:51]
    v_mfma_f32_16x16x32_bf16 v[52:55], v[136:139], v[200:203], v[52:55]
    v_mov_b32_dpp v210, v208 row_ror:8 row_mask:0xf bank_mask:0xf
    v_mov_b32_dpp v211, v209 row_ror:8 row_mask:0xf bank_mask:0xf
    v_mfma_f32_16x16x32_bf16 v[56:59], v[168:171], v[200:203], v[56:59]
    v_mfma_f32_16x16x32_bf16 v[44:47], v[76:79], v[204:207], v[44:47]
    v_perm_b32 v212, v213, v212, s71
    v_perm_b32 v213, v215, v214, s71
    v_mfma_f32_16x16x32_bf16 v[48:51], v[108:111], v[204:207], v[48:51]
    v_mfma_f32_16x16x32_bf16 v[52:55], v[140:143], v[204:207], v[52:55]
    v_mov_b32_dpp v214, v212 row_ror:8 row_mask:0xf bank_mask:0xf
    v_mov_b32_dpp v215, v213 row_ror:8 row_mask:0xf bank_mask:0xf
    v_mfma_f32_16x16x32_bf16 v[56:59], v[172:175], v[204:207], v[56:59]
    v_mfma_f32_16x16x32_bf16 v[44:47], v[80:83], v[208:211], v[44:47]
    v_perm_b32 v216, v217, v216, s71
    v_perm_b32 v217, v219, v218, s71
    v_mfma_f32_16x16x32_bf16 v[48:51], v[112:115], v[208:211], v[48:51]
    v_mfma_f32_16x16x32_bf16 v[52:55], v[144:147], v[208:211], v[52:55]
    v_mov_b32_dpp v218, v216 row_ror:8 row_mask:0xf bank_mask:0xf
    v_mov_b32_dpp v219, v217 row_ror:8 row_mask:0xf bank_mask:0xf
    v_mfma_f32_16x16x32_bf16 v[56:59], v[176:179], v[208:211], v[56:59]
    v_mfma_f32_16x16x32_bf16 v[44:47], v[84:87], v[212:215], v[44:47]
    v_perm_b32 v220, v221, v220, s71
    v_perm_b32 v221, v223, v222, s71
    v_mfma_f32_16x16x32_bf16 v[48:51], v[116:119], v[212:215], v[48:51]
    v_mfma_f32_16x16x32_bf16 v[52:55], v[148:151], v[212:215], v[52:55]
    v_mov_b32_dpp v222, v220 row_ror:8 row_mask:0xf bank_mask:0xf
    v_mov_b32_dpp v223, v221 row_ror:8 row_mask:0xf bank_mask:0xf
    v_mfma_f32_16x16x32_bf16 v[56:59], v[180:183], v[212:215], v[56:59]
    v_mfma_f32_16x16x32_bf16 v[44:47], v[88:91], v[216:219], v[44:47]
    v_mfma_f32_16x16x32_bf16 v[48:51], v[120:123], v[216:219], v[48:51]
    v_mfma_f32_16x16x32_bf16 v[52:55], v[152:155], v[216:219], v[52:55]
    v_mfma_f32_16x16x32_bf16 v[56:59], v[184:187], v[216:219], v[56:59]
    v_mfma_f32_16x16x32_bf16 v[44:47], v[92:95], v[220:223], v[44:47]
    v_mfma_f32_16x16x32_bf16 v[48:51], v[124:127], v[220:223], v[48:51]
    v_mfma_f32_16x16x32_bf16 v[52:55], v[156:159], v[220:223], v[52:55]
    v_mfma_f32_16x16x32_bf16 v[56:59], v[188:191], v[220:223], v[56:59]
    s_nop 5
    v_mov_b32_dpp v44, v48 row_ror:8 row_mask:0xf bank_mask:0xc
    v_mov_b32_dpp v45, v49 row_ror:8 row_mask:0xf bank_mask:0xc
    v_mov_b32_dpp v46, v50 row_ror:8 row_mask:0xf bank_mask:0xc
    v_mov_b32_dpp v47, v51 row_ror:8 row_mask:0xf bank_mask:0xc
    v_bfi_b32 v44, s59, v44, v60
    v_bfi_b32 v45, s59, v45, v61
    v_bfi_b32 v46, s59, v46, v62
    v_bfi_b32 v47, s59, v47, v63
    buffer_store_dwordx4 v[44:47], v14, s[48:51], s74 offen offset:0 sc1
    v_mov_b32_dpp v52, v56 row_ror:8 row_mask:0xf bank_mask:0xc
    v_mov_b32_dpp v53, v57 row_ror:8 row_mask:0xf bank_mask:0xc
    v_mov_b32_dpp v54, v58 row_ror:8 row_mask:0xf bank_mask:0xc
    v_mov_b32_dpp v55, v59 row_ror:8 row_mask:0xf bank_mask:0xc
    v_bfi_b32 v52, s59, v52, v60
    v_bfi_b32 v53, s59, v53, v61
    v_bfi_b32 v54, s59, v54, v62
    v_bfi_b32 v55, s59, v55, v63
    buffer_store_dwordx4 v[52:55], v14, s[48:51], s74 offen offset:2048 sc1
L_hbend:
    s_endpgm
L_FIN:
    s_sub_u32 s64, s2, 0
    s_mul_i32 s76, s64, 3641
    s_lshr_b32 s76, s76, 16
    s_mul_i32 s77, s76, 18
    s_sub_u32 s77, s64, s77
    s_mul_i32 s56, s76, 1152
    s_add_u32 s57, s56, 1152
    s_mov_b32 s63, 0xffff0000
    s_mov_b32 s32, s4
    s_mov_b32 s33, s5
    s_mov_b32 s34, s57
    s_mov_b32 s35, 0x20000
    s_mov_b32 s36, s22
    s_mov_b32 s37, s23
    s_mov_b32 s38, 1152
    s_mov_b32 s39, 0x20000
    v_lshlrev_b32 v5, 5, v0
    v_lshlrev_b32 v15, 3, v0
    buffer_load_dwordx4 v[16:19], v5, s[32:35], s56 offen
    buffer_load_dwordx4 v[20:23], v5, s[32:35], s56 offen offset:16
    buffer_load_dwordx4 v[24:27], v5, s[36:39], 0 offen
    buffer_load_dwordx4 v[28:31], v5, s[36:39], 0 offen offset:16
    s_mov_b32 s58, 0x3f803f80
    v_mov_b32 v32, 0
    s_waitcnt vmcnt(0)
    v_lshlrev_b32 v34, 16, v16
    v_and_b32 v35, s63, v16
    v_lshlrev_b32 v36, 16, v24
    v_and_b32 v37, s63, v24
    v_mul_f32 v34, v34, v36
    v_mul_f32 v35, v35, v37
    v_cvt_pk_bf16_f32 v34, v34, v35
    v_dot2_f32_bf16 v32, v34, s58, v32
    v_lshlrev_b32 v34, 16, v17
    v_and_b32 v35, s63, v17
    v_lshlrev_b32 v36, 16, v25
    v_and_b32 v37, s63, v25
    v_mul_f32 v34, v34, v36
    v_mul_f32 v35, v35, v37
    v_cvt_pk_bf16_f32 v34, v34, v35
    v_dot2_f32_bf16 v32, v34, s58, v32
    v_lshlrev_b32 v34, 16, v18
    v_and_b32 v35, s63, v18
    v_lshlrev_b32 v36, 16, v26
    v_and_b32 v37, s63, v26
    v_mul_f32 v34, v34, v36
    v_mul_f32 v35, v35, v37
    v_cvt_pk_bf16_f32 v34, v34, v35
    v_dot2_f32_bf16 v32, v34, s58, v32
    v_lshlrev_b32 v34, 16, v19
    v_and_b32 v35, s63, v19
    v_lshlrev_b32 v36, 16, v27
    v_and_b32 v37, s63, v27
    v_mul_f32 v34, v34, v36
    v_mul_f32 v35, v35, v37
    v_cvt_pk_bf16_f32 v34, v34, v35
    v_dot2_f32_bf16 v32, v34, s58, v32
    v_lshlrev_b32 v34, 16, v20
    v_and_b32 v35, s63, v20
    v_lshlrev_b32 v36, 16, v28
    v_and_b32 v37, s63, v28
    v_mul_f32 v34, v34, v36
    v_mul_f32 v35, v35, v37
    v_cvt_pk_bf16_f32 v34, v34, v35
    v_dot2_f32_bf16 v32, v34, s58, v32
    v_lshlrev_b32 v34, 16, v21
    v_and_b32 v35, s63, v21
    v_lshlrev_b32 v36, 16, v29
    v_and_b32 v37, s63, v29
    v_mul_f32 v34, v34, v36
    v_mul_f32 v35, v35, v37
    v_cvt_pk_bf16_f32 v34, v34, v35
    v_dot2_f32_bf16 v32, v34, s58, v32
    v_lshlrev_b32 v34, 16, v22
    v_and_b32 v35, s63, v22
    v_lshlrev_b32 v36, 16, v30
    v_and_b32 v37, s63, v30
    v_mul_f32 v34, v34, v36
    v_mul_f32 v35, v35, v37
    v_cvt_pk_bf16_f32 v34, v34, v35
    v_dot2_f32_bf16 v32, v34, s58, v32
    v_lshlrev_b32 v34, 16, v23
    v_and_b32 v35, s63, v23
    v_lshlrev_b32 v36, 16, v31
    v_and_b32 v37, s63, v31
    v_mul_f32 v34, v34, v36
    v_mul_f32 v35, v35, v37
    v_cvt_pk_bf16_f32 v34, v34, v35
    v_dot2_f32_bf16 v32, v34, s58, v32
    s_nop 2
    v_add_f32_dpp v32, v32, v32 quad_perm:[1,0,3,2] row_mask:0xf bank_mask:0xf
    s_nop 1
    v_add_f32_dpp v32, v32, v32 quad_perm:[2,3,0,1] row_mask:0xf bank_mask:0xf
    s_nop 1
    v_add_f32_dpp v32, v32, v32 row_half_mirror row_mask:0xf bank_mask:0xf
    s_nop 1
    v_add_f32_dpp v32, v32, v32 row_ror:8 row_mask:0xf bank_mask:0xf
    v_mov_b32 v34, v32
    s_nop 1
    v_permlane16_swap_b32 v32, v34
    v_add_f32 v32, v32, v34
    v_mov_b32 v34, v32
    s_nop 1
    v_permlane32_swap_b32 v32, v34
    v_add_f32 v32, v32, v34
    v_cvt_pk_bf16_f32 v32, v32, v32
    v_and_b32 v32, s63, v32
    v_mul_f32 v32, 0xbfb8aa3b, v32
    v_exp_f32 v32, v32
    s_nop 0
    v_add_f32 v32, 1.0, v32
    v_rcp_f32 v32, v32
    s_nop 0
    v_cvt_pk_bf16_f32 v32, v32, v32
    v_and_b32 v168, s63, v32
    v_sub_f32 v33, 1.0, v168
    v_cvt_pk_bf16_f32 v33, v33, v33
    v_and_b32 v33, s63, v33
    s_lshl_b32 s56, s64, 10
    s_add_u32 s56, s56, 655360
    s_barrier
    s_barrier
    s_mov_b32 s62, 524288
L_poll_19:
    buffer_load_dwordx4 v[164:167], v1, s[48:51], s56 offen sc1 nt
    s_waitcnt vmcnt(0)
    v_xor_b32 v2, v164, v60
    v_xor_b32 v3, v165, v61
    v_bitop3_b32 v2, v2, v166, v62 bitop3:0xf6
    v_bitop3_b32 v3, v3, v167, v63 bitop3:0xf6
    v_or_b32 v2, v2, v3
    v_and_b32 v2, 0xff, v2
    v_cmp_ne_u32 vcc, 0, v2
    s_cbranch_vccz L_pdone_20
    s_sleep 64
    s_sub_u32 s62, s62, 1
    s_cbranch_scc0 L_poll_19
L_pdone_20:
    s_mov_b64 exec, -1
    v_and_b32 v164, s59, v164
    v_and_b32 v165, s59, v165
    v_and_b32 v166, s59, v166
    v_and_b32 v167, s59, v167
    v_add_f32_dpp v164, v164, v164 row_ror:8 row_mask:0xf bank_mask:0xf
    v_add_f32_dpp v165, v165, v165 row_ror:8 row_mask:0xf bank_mask:0xf
    v_add_f32_dpp v166, v166, v166 row_ror:8 row_mask:0xf bank_mask:0xf
    v_add_f32_dpp v167, v167, v167 row_ror:8 row_mask:0xf bank_mask:0xf
    v_mov_b32 v40, v164
    v_mov_b32 v41, v165
    v_mov_b32 v42, v166
    v_mov_b32 v43, v167
    v_permlane16_swap_b32 v164, v40
    v_permlane16_swap_b32 v165, v41
    v_permlane16_swap_b32 v166, v42
    v_permlane16_swap_b32 v167, v43
    v_add_f32 v164, v164, v40
    v_add_f32 v165, v165, v41
    v_add_f32 v166, v166, v42
    v_add_f32 v167, v167, v43
    v_mov_b32 v40, v164
    v_mov_b32 v41, v165
    v_mov_b32 v42, v166
    v_mov_b32 v43, v167
    v_permlane32_swap_b32 v164, v40
    v_permlane32_swap_b32 v165, v41
    v_permlane32_swap_b32 v166, v42
    v_permlane32_swap_b32 v167, v43
    v_add_f32 v164, v164, v40
    v_add_f32 v165, v165, v41
    v_add_f32 v166, v166, v42
    v_add_f32 v167, v167, v43
    v_cvt_pk_bf16_f32 v40, v164, v165
    v_cvt_pk_bf16_f32 v41, v166, v167
    v_lshlrev_b32 v164, 16, v40
    v_and_b32 v165, s63, v40
    v_lshlrev_b32 v166, 16, v41
    v_and_b32 v167, s63, v41
    v_mul_f32 v164, v33, v164
    v_mul_f32 v165, v33, v165
    v_mul_f32 v166, v33, v166
    v_mul_f32 v167, v33, v167
    v_cvt_pk_bf16_f32 v40, v164, v165
    v_cvt_pk_bf16_f32 v41, v166, v167
    v_lshlrev_b32 v164, 16, v40
    v_and_b32 v165, s63, v40
    v_lshlrev_b32 v166, 16, v41
    v_and_b32 v167, s63, v41
    s_lshl_b32 s56, s77, 6
    v_mov_b32 v13, v1
    s_lshl_b32 s78, s64, 11
    s_add_u32 s78, s78, 1310720
    s_add_u32 s77, s78, 1024
    s_mul_i32 s79, s76, 1152
    s_add_u32 s79, s79, s56
    s_mov_b32 s32, s24
    s_mov_b32 s33, s25
    s_mov_b32 s34, 9216
    s_mov_b32 s35, 0x20000
    s_barrier
    s_barrier
    s_setprio 3
    s_barrier
    s_barrier
    s_mov_b32 s62, 2097152
L_poll_21:
    buffer_load_dwordx4 v[16:19], v13, s[48:51], s78 offen sc1
    buffer_load_dwordx4 v[20:23], v13, s[48:51], s77 offen sc1
    s_waitcnt vmcnt(0)
    v_xor_b32 v2, v16, v60
    v_xor_b32 v3, v17, v61
    v_bitop3_b32 v2, v2, v18, v62 bitop3:0xf6
    v_bitop3_b32 v3, v3, v19, v63 bitop3:0xf6
    v_bitop3_b32 v2, v2, v20, v60 bitop3:0xf6
    v_bitop3_b32 v3, v3, v21, v61 bitop3:0xf6
    v_bitop3_b32 v2, v2, v22, v62 bitop3:0xf6
    v_bitop3_b32 v3, v3, v23, v63 bitop3:0xf6
    v_or_b32 v2, v2, v3
    v_and_b32 v2, 0xff, v2
    v_cmp_ne_u32 vcc, 0, v2
    s_cbranch_vccz L_pdone_22
    s_mov_b64 exec, vcc
    s_sleep 2
    s_sub_u32 s62, s62, 1
    s_cbranch_scc0 L_poll_21
L_pdone_22:
    s_mov_b64 exec, -1
    v_and_b32 v16, s59, v16
    v_and_b32 v17, s59, v17
    v_and_b32 v18, s59, v18
    v_and_b32 v19, s59, v19
    v_and_b32 v20, s59, v20
    v_and_b32 v21, s59, v21
    v_and_b32 v22, s59, v22
    v_and_b32 v23, s59, v23
    v_add_f32 v16, v16, v20
    v_add_f32 v17, v17, v21
    v_add_f32 v18, v18, v22
    v_add_f32 v19, v19, v23
    v_add_f32_dpp v16, v16, v16 row_ror:8 row_mask:0xf bank_mask:0xf
    v_add_f32_dpp v17, v17, v17 row_ror:8 row_mask:0xf bank_mask:0xf
    v_add_f32_dpp v18, v18, v18 row_ror:8 row_mask:0xf bank_mask:0xf
    v_add_f32_dpp v19, v19, v19 row_ror:8 row_mask:0xf bank_mask:0xf
    v_mov_b32 v20, v16
    v_mov_b32 v21, v17
    v_mov_b32 v22, v18
    v_mov_b32 v23, v19
    v_permlane16_swap_b32 v16, v20
    v_permlane16_swap_b32 v17, v21
    v_permlane16_swap_b32 v18, v22
    v_permlane16_swap_b32 v19, v23
    v_add_f32 v16, v16, v20
    v_add_f32 v17, v17, v21
    v_add_f32 v18, v18, v22
    v_add_f32 v19, v19, v23
    v_mov_b32 v20, v16
    v_mov_b32 v21, v17
    v_mov_b32 v22, v18
    v_mov_b32 v23, v19
    v_permlane32_swap_b32 v16, v20
    v_permlane32_swap_b32 v17, v21
    v_permlane32_swap_b32 v18, v22
    v_permlane32_swap_b32 v19, v23
    v_add_f32 v16, v16, v20
    v_add_f32 v17, v17, v21
    v_add_f32 v18, v18, v22
    v_add_f32 v19, v19, v23
    v_cvt_pk_bf16_f32 v20, v16, v17
    v_cvt_pk_bf16_f32 v21, v18, v19
    v_lshlrev_b32 v16, 16, v20
    v_and_b32 v17, s63, v20
    v_lshlrev_b32 v18, 16, v21
    v_and_b32 v19, s63, v21
    v_mul_f32 v16, v168, v16
    v_mul_f32 v17, v168, v17
    v_mul_f32 v18, v168, v18
    v_mul_f32 v19, v168, v19
    v_cvt_pk_bf16_f32 v20, v16, v17
    v_cvt_pk_bf16_f32 v21, v18, v19
    v_lshlrev_b32 v16, 16, v20
    v_and_b32 v17, s63, v20
    v_lshlrev_b32 v18, 16, v21
    v_and_b32 v19, s63, v21
    v_add_f32 v16, v16, v164
    v_add_f32 v17, v17, v165
    v_add_f32 v18, v18, v166
    v_add_f32 v19, v19, v167
    v_cvt_pk_bf16_f32 v20, v16, v17
    v_cvt_pk_bf16_f32 v21, v18, v19
    s_mov_b64 exec, 0xff
    buffer_store_dwordx2 v[20:21], v15, s[32:35], s79 offen
    s_cmp_lg_u32 s64, 0
    s_cbranch_scc1 L_noepoch
    s_mov_b64 exec, 1
    v_mov_b32 v2, s88
    v_mov_b32 v3, 0
    buffer_store_dword v2, v3, s[48:51], 0 offen sc1
L_noepoch:
    s_mov_b64 exec, -1
L_end:
    s_endpgm
.section .rodata,"a"
.p2align 6
.amdhsa_kernel gated_mix__mha_block_cached__swiglu_ffn__decode_kernel
  .amdhsa_next_free_vgpr 224
  .amdhsa_next_free_sgpr 102
  .amdhsa_accum_offset 224
  .amdhsa_group_segment_fixed_size 0
  .amdhsa_kernarg_size 104
  .amdhsa_user_sgpr_count 2
  .amdhsa_user_sgpr_kernarg_segment_ptr 1
  .amdhsa_system_sgpr_workgroup_id_x 1
.end_amdhsa_kernel
```
